```python
import torch

def _softmax(x, axis=-1):
    return torch.softmax(x, dim=axis)
def _gelu(x):
    return torch.nn.functional.gelu(x, approximate="tanh")
def _silu(x):
    return torch.nn.functional.silu(x)
def _sigmoid(x):
    return torch.sigmoid(x)
def _layernorm(x, axis=-1, eps=1e-5):
    m = x.mean(dim=axis, keepdim=True)
    v = x.var(dim=axis, keepdim=True, unbiased=False)
    return (x - m) / torch.sqrt(v + eps)
def _scatter_add(tgt, idx, src, axis=0):
    return tgt.clone().index_add_(axis, idx, src)
def _segment_sum(src, seg, n):
    out = torch.zeros((n,) + src.shape[1:], dtype=src.dtype)
    return out.index_add_(0, seg, src)
def _pad(x, pw):
    flat = tuple(v for pair in reversed(pw) for v in pair)
    return torch.nn.functional.pad(x, flat)

kernel_name = 'gated_mix__mha_block__spectral_fnet__prompt'

def setup_inputs():

    _w = (lambda a: (lambda t: t.to(torch.bfloat16) if t.is_floating_point() else t)(torch.as_tensor(a)))
    def _A_setup():
        B, S, D, H = 1, 2048, 640, 32
        return {
            "x": _w((lambda *s: torch.randn(*s, dtype=torch.bfloat16) * 0.05)(B, S, D)),
            "wqkv": _w((lambda *s: torch.randn(*s, dtype=torch.bfloat16) * 1.6)(D, 3 * D)),
            "wo": _w((lambda *s: torch.randn(*s, dtype=torch.bfloat16) * 1.6)(D, D)),
        }
    _A_in = _A_setup()

    def _B_setup():
        B, S, D = 1, 2048, 640
        ns = torch.arange(S)[:, None] * torch.arange(S)[None, :]
        nd = torch.arange(D)[:, None] * torch.arange(D)[None, :]
        Ws_re = torch.cos(-2.0 * torch.pi * ns / S).to(float)
        Ws_im = torch.sin(-2.0 * torch.pi * ns / S).to(float)
        Wd_re = torch.cos(-2.0 * torch.pi * nd / D).to(float)
        Wd_im = torch.sin(-2.0 * torch.pi * nd / D).to(float)
        return {
            "x": _w((lambda *s: torch.randn(*s, dtype=torch.bfloat16) * 0.05)(B, S, D)),
            "dft_seq_re": _w(Ws_re),
            "dft_seq_im": _w(Ws_im),
            "dft_hid_re": _w(Wd_re),
            "dft_hid_im": _w(Wd_im),
        }
    _B_in = _B_setup()

    return {
        "A_x": _A_in["x"],
        "A_wqkv": _A_in["wqkv"],
        "A_wo": _A_in["wo"],
        "B_x": _B_in["x"],
        "B_dft_seq_re": _B_in["dft_seq_re"],
        "B_dft_seq_im": _B_in["dft_seq_im"],
        "B_dft_hid_re": _B_in["dft_hid_re"],
        "B_dft_hid_im": _B_in["dft_hid_im"],
        "gate_w": _w((lambda *s: torch.randn(*s, dtype=torch.bfloat16) * 0.05)(640) * 16.0),
    }

def reference(A_x, A_wqkv, A_wo, B_x, B_dft_seq_re, B_dft_seq_im, B_dft_hid_re, B_dft_hid_im, gate_w):
    def _A_ref(x, wqkv, wo):
        B, S, D = x.shape
        H = 32
        Dh = D // H
        qkv = (lambda x, *d: x.permute(*d))((x @ wqkv).reshape(B, S, 3, H, Dh), 2, 0, 3, 1, 4)
        q, k, v = qkv[0], qkv[1], qkv[2]
        scores = torch.einsum("bhqd,bhkd->bhqk", q, k) * (Dh ** -0.5)
        p = _softmax(scores, axis=-1)
        o = torch.einsum("bhqk,bhkd->bhqd", p, v)
        return (lambda x, *d: x.permute(*d))(o, 0, 2, 1, 3).reshape(B, S, D) @ wo

    def _B_ref(x, dft_seq_re, dft_seq_im, dft_hid_re, dft_hid_im):
        a = torch.einsum("bsd,ed->bse", x, dft_hid_re)
        b = torch.einsum("bsd,ed->bse", x, dft_hid_im)
        y = torch.einsum("ts,bse->bte", dft_seq_re, a) - torch.einsum("ts,bse->bte", dft_seq_im, b)
        return y

    x = A_x
    g = _sigmoid((x * gate_w).sum(-1, keepdims=True))
    a = _A_ref(x, A_wqkv, A_wo)
    b = _B_ref(x, B_dft_seq_re, B_dft_seq_im, B_dft_hid_re, B_dft_hid_im)
    return g * a + (1 - g) * b
```

```asm
; @launch kernel=k1_kernel grid=(256,1,1) block=(512,1,1) lds=147456
; @launch kernel=k2_kernel grid=(256,1,1) block=(768,1,1) lds=86528
; @launch kernel=k3_kernel grid=(256,1,1) block=(256,1,1) lds=61440
.amdgcn_target "amdgcn-amd-amdhsa--gfx950"
.text
.globl k1_kernel
.p2align 8
.type k1_kernel,@function
k1_kernel:
    s_cmp_ge_u32 s2, 256
    s_cbranch_scc1 K1_end
    s_getpc_b64 s[84:85]
K1_pc:
    v_lshlrev_b32 v2, 7, v0
    v_min_u32 v2, TEXT_END-K1_pc-4, v2
    global_load_dword v127, v2, s[84:85]
    s_load_dwordx4 s[4:7], s[0:1], 0
    s_load_dwordx4 s[8:11], s[0:1], 48
    s_load_dwordx2 s[12:13], s[0:1], 88
    s_load_dwordx2 s[56:57], s[0:1], 16
    v_lshrrev_b32 v1, 6, v0
    v_and_b32 v0, 63, v0
    s_and_b32 s18, s2, 7
    s_lshr_b32 s19, s2, 3
    v_readfirstlane_b32 s16, v1
    s_and_b32 s14, s18, 1
    s_lshl_b32 s14, s14, 3
    s_and_b32 s3, s19, 7
    s_add_u32 s14, s14, s3
    s_lshr_b32 s17, s19, 3
    s_lshl_b32 s15, s17, 2
    s_lshr_b32 s3, s18, 1
    s_add_u32 s15, s15, s3
    s_cmp_ge_u32 s16, 4
    s_cbranch_scc0 K1_compute
    s_sub_u32 s16, s16, 4
    v_lshrrev_b32 v1, 3, v0
    v_and_b32 v5, 7, v0
    v_xor_b32 v5, v5, v1
    v_lshlrev_b32 v5, 4, v5
    s_lshl_b32 s38, s14, 5
    s_lshr_b32 s3, s16, 1
    s_lshl_b32 s3, s3, 4
    s_add_u32 s38, s38, s3
    s_and_b32 s3, s16, 1
    s_cmp_eq_u32 s3, 1
    s_mov_b32 s40, 1280
    s_cselect_b32 s40, -1280, s40
    s_cselect_b32 s34, 2621440, 0
    s_mul_i32 s38, s38, s40
    s_add_u32 s34, s34, s38
    s_sub_u32 s36, 1310720, s38
    s_lshl_b32 s3, s40, 3
    s_add_u32 s35, s34, s3
    s_sub_u32 s37, s36, s3
    v_mul_i32_i24 v4, s40, v1
    v_sub_u32 v3, v5, v4
    v_add_u32 v4, v5, v4
    v_add_u32 v8, s34, v4
    v_add_u32 v6, s35, v4
    v_add_u32 v7, s36, v3
    v_add_u32 v11, s37, v3
    v_cmp_le_u32 vcc, 2621440, v8
    v_subrev_u32 v2, 1966080, v8
    v_add_u32 v3, 655360, v7
    s_cmp_eq_u32 s17, 2
    s_cselect_b64 s[34:35], -1, 0
    v_cndmask_b32 v8, v8, v2, vcc
    v_cndmask_b32 v7, v7, v3, vcc
    v_cndmask_b32 v9, v6, v7, s[34:35]
    v_cndmask_b32 v10, v7, v6, s[34:35]
    s_waitcnt lgkmcnt(0)
    s_mov_b32 s20, s4
    s_mov_b32 s21, s5
    s_mov_b32 s22, 2621440
    s_mov_b32 s23, 0x20000
    s_cmp_ge_u32 s15, 14
    s_cselect_b64 s[24:25], s[10:11], s[8:9]
    s_cmp_lt_u32 s15, 12
    s_cselect_b64 s[24:25], s[6:7], s[24:25]
    s_mov_b32 s26, 819200
    s_cselect_b32 s26, 2457600, s26
    s_mov_b32 s27, 0x20000
    s_mov_b32 s32, 1280
    s_cselect_b32 s32, 3840, s32
    s_and_b32 s33, s15, 1
    s_cmp_lt_u32 s15, 12
    s_cselect_b32 s33, s15, s33
    s_mul_i32 s33, s33, 320
    s_lshl_b32 s44, s32, 6
    s_lshl_b32 s41, s16, 12
    s_mul_i32 s42, s16, 5120
    s_add_u32 s42, s42, 16384
    s_mul_i32 s3, s16, 320
    v_add_u32 v1, s3, v0
    s_mul_i32 s3, s17, 5
    s_lshr_b32 s3, s3, 1
    s_and_b32 s45, s14, 7
    s_add_u32 s45, s45, s3
    s_sub_u32 s3, s45, 10
    s_cmp_ge_u32 s45, 10
    s_cselect_b32 s45, s3, s45
    s_mul_i32 s46, s45, s44
    s_lshl_b32 s45, s45, 7
    s_mov_b32 s47, 0
    s_mov_b32 s43, 0
    s_add_u32 m0, s41, 0
    s_nop 0
    buffer_load_dwordx4 v8, s[20:23], s45 offen lds
    s_add_u32 m0, s41, 1024
    s_nop 0
    buffer_load_dwordx4 v9, s[20:23], s45 offen lds
    s_add_u32 m0, s41, 2048
    s_nop 0
    buffer_load_dwordx4 v10, s[20:23], s45 offen lds
    s_add_u32 m0, s41, 3072
    s_nop 0
    buffer_load_dwordx4 v11, s[20:23], s45 offen lds
    v_add_u32 v2, 0, v1
    v_mul_u32_u24 v3, 3277, v2
    v_lshrrev_b32 v3, 16, v3
    v_mul_u32_u24 v4, 20, v3
    v_sub_u32 v4, v2, v4
    v_lshrrev_b32 v5, 2, v3
    v_and_b32 v5, 2, v5
    v_xor_b32 v4, v4, v5
    v_lshl_add_u32 v4, v4, 4, s33
    v_mad_u32_u24 v12, v3, s32, v4
    s_add_u32 m0, s42, 0
    s_nop 0
    buffer_load_dwordx4 v12, s[24:27], s46 offen lds
    v_add_u32 v2, 64, v1
    v_mul_u32_u24 v3, 3277, v2
    v_lshrrev_b32 v3, 16, v3
    v_mul_u32_u24 v4, 20, v3
    v_sub_u32 v4, v2, v4
    v_lshrrev_b32 v5, 2, v3
    v_and_b32 v5, 2, v5
    v_xor_b32 v4, v4, v5
    v_lshl_add_u32 v4, v4, 4, s33
    v_mad_u32_u24 v13, v3, s32, v4
    s_add_u32 m0, s42, 1024
    s_nop 0
    buffer_load_dwordx4 v13, s[24:27], s46 offen lds
    v_add_u32 v2, 128, v1
    v_mul_u32_u24 v3, 3277, v2
    v_lshrrev_b32 v3, 16, v3
    v_mul_u32_u24 v4, 20, v3
    v_sub_u32 v4, v2, v4
    v_lshrrev_b32 v5, 2, v3
    v_and_b32 v5, 2, v5
    v_xor_b32 v4, v4, v5
    v_lshl_add_u32 v4, v4, 4, s33
    v_mad_u32_u24 v14, v3, s32, v4
    s_add_u32 m0, s42, 2048
    s_nop 0
    buffer_load_dwordx4 v14, s[24:27], s46 offen lds
    v_add_u32 v2, 192, v1
    v_mul_u32_u24 v3, 3277, v2
    v_lshrrev_b32 v3, 16, v3
    v_mul_u32_u24 v4, 20, v3
    v_sub_u32 v4, v2, v4
    v_lshrrev_b32 v5, 2, v3
    v_and_b32 v5, 2, v5
    v_xor_b32 v4, v4, v5
    v_lshl_add_u32 v4, v4, 4, s33
    v_mad_u32_u24 v15, v3, s32, v4
    s_add_u32 m0, s42, 3072
    s_nop 0
    buffer_load_dwordx4 v15, s[24:27], s46 offen lds
    v_add_u32 v2, 256, v1
    v_mul_u32_u24 v3, 3277, v2
    v_lshrrev_b32 v3, 16, v3
    v_mul_u32_u24 v4, 20, v3
    v_sub_u32 v4, v2, v4
    v_lshrrev_b32 v5, 2, v3
    v_and_b32 v5, 2, v5
    v_xor_b32 v4, v4, v5
    v_lshl_add_u32 v4, v4, 4, s33
    v_mad_u32_u24 v16, v3, s32, v4
    s_add_u32 m0, s42, 4096
    s_nop 0
    buffer_load_dwordx4 v16, s[24:27], s46 offen lds
    s_mul_i32 s52, s2, 3277
    s_lshr_b32 s52, s52, 16
    s_mul_i32 s3, s52, 20
    s_sub_u32 s53, s2, s3
    s_lshl_b32 s52, s52, 2
    s_add_u32 s52, s52, s16
    v_and_b32 v2, 15, v0
    v_lshrrev_b32 v3, 4, v0
    v_lshrrev_b32 v4, 1, v3
    v_mul_u32_u24 v4, 20, v4
    v_and_b32 v5, 1, v3
    v_lshl_add_u32 v4, v5, 2, v4
    v_mul_u32_u24 v5, 40, v3
    v_add_u32 v5, 16, v5
    s_mul_i32 s54, s53, 40
    s_sub_u32 s3, s53, 16
    s_mul_i32 s3, s3, 160
    s_mov_b32 s55, 10240
    s_cmp_ge_u32 s53, 16
    s_cselect_b32 s54, s3, s54
    s_cselect_b32 s55, 25600, s55
    s_cselect_b64 s[34:35], -1, 0
    v_cndmask_b32 v4, v4, v5, s[34:35]
    v_add_u32 v4, s54, v4
    v_mul_u32_u24 v4, 1280, v4
    v_lshl_add_u32 v4, v2, 1, v4
    s_lshl_b32 s54, s52, 5
    s_add_u32 s55, s55, s54
    s_mov_b32 s58, 819200
    s_cmp_ge_u32 s2, 200
    s_cselect_b32 s58, 0, s58
    s_mov_b32 s59, 0x20000
    buffer_load_ushort v24, v4, s[56:59], s54 offen offset:0
    buffer_load_ushort v25, v4, s[56:59], s54 offen offset:1280
    buffer_load_ushort v26, v4, s[56:59], s54 offen offset:2560
    buffer_load_ushort v27, v4, s[56:59], s54 offen offset:3840
    buffer_load_ushort v28, v4, s[56:59], s55 offen offset:0
    buffer_load_ushort v29, v4, s[56:59], s55 offen offset:1280
    buffer_load_ushort v30, v4, s[56:59], s55 offen offset:2560
    buffer_load_ushort v31, v4, s[56:59], s55 offen offset:3840
    s_branch K1_ld_next
K1_ld:
    s_add_u32 s50, s47, s41
    s_add_u32 s51, s47, s42
    s_add_u32 m0, s50, 0
    s_nop 0
    buffer_load_dwordx4 v8, s[20:23], s45 offen lds
    s_add_u32 m0, s50, 1024
    s_nop 0
    buffer_load_dwordx4 v9, s[20:23], s45 offen lds
    s_add_u32 m0, s50, 2048
    s_nop 0
    buffer_load_dwordx4 v10, s[20:23], s45 offen lds
    s_add_u32 m0, s50, 3072
    s_nop 0
    buffer_load_dwordx4 v11, s[20:23], s45 offen lds
    s_add_u32 m0, s51, 0
    s_nop 0
    buffer_load_dwordx4 v12, s[24:27], s46 offen lds
    s_add_u32 m0, s51, 1024
    s_nop 0
    buffer_load_dwordx4 v13, s[24:27], s46 offen lds
    s_add_u32 m0, s51, 2048
    s_nop 0
    buffer_load_dwordx4 v14, s[24:27], s46 offen lds
    s_add_u32 m0, s51, 3072
    s_nop 0
    buffer_load_dwordx4 v15, s[24:27], s46 offen lds
    s_add_u32 m0, s51, 4096
    s_nop 0
    buffer_load_dwordx4 v16, s[24:27], s46 offen lds
K1_ld_next:
    s_add_u32 s45, s45, 128
    s_add_u32 s46, s46, s44
    s_cmp_eq_u32 s45, 1280
    s_cselect_b32 s45, 0, s45
    s_cselect_b32 s46, 0, s46
    s_add_u32 s47, s47, 36864
    s_cmp_eq_u32 s47, 147456
    s_cselect_b32 s47, 0, s47
    s_add_u32 s43, s43, 1
    s_cmp_eq_u32 s43, 2
    s_cbranch_scc0 K1_ld_b
    s_waitcnt vmcnt(17)
    s_barrier
K1_ld_b:
    s_cmp_lt_u32 s43, 4
    s_cbranch_scc1 K1_ld
    s_waitcnt vmcnt(18)
    s_barrier
    s_cmp_lt_u32 s43, 10
    s_cbranch_scc1 K1_ld
    s_waitcnt vmcnt(9)
    s_barrier
    s_waitcnt vmcnt(0)
    s_barrier
    s_cmp_ge_u32 s2, 200
    s_cbranch_scc1 K1_ld_end
    s_mul_i32 s3, s52, 20
    s_add_u32 s3, s3, s53
    s_lshl_b32 s3, s3, 10
    s_add_u32 s3, s3, 15138816
    s_mov_b32 s28, s12
    s_mov_b32 s29, s13
    s_mov_b32 s30, 268435456
    s_mov_b32 s31, 0x20000
    v_lshl_or_b32 v32, v25, 16, v24
    v_lshl_or_b32 v33, v27, 16, v26
    v_lshl_or_b32 v34, v29, 16, v28
    v_lshl_or_b32 v35, v31, 16, v30
    v_lshlrev_b32 v2, 4, v0
    buffer_store_dwordx4 v[32:35], v2, s[28:31], s3 offen
K1_ld_end:
    s_endpgm
K1_compute:
    s_lshr_b32 s18, s16, 1
    s_and_b32 s19, s16, 1
    v_and_b32 v1, 15, v0
    v_lshrrev_b32 v2, 4, v0
    v_and_b32 v3, 7, v0
    v_xor_b32 v3, v3, v2
    s_lshl_b32 s3, s18, 13
    v_lshlrev_b32 v4, 7, v1
    v_add_u32 v4, s3, v4
    v_lshl_add_u32 v111, v3, 4, v4
    v_xor_b32 v112, 64, v111
    v_bfe_u32 v5, v0, 2, 2
    v_and_b32 v6, 3, v0
    v_lshl_add_u32 v5, v2, 3, v5
    v_mul_u32_u24 v5, 320, v5
    v_add_u32 v5, 16384, v5
    s_mov_b32 s34, 8
    s_mov_b32 s35, 32
    s_cmp_lt_u32 s17, 2
    s_cselect_b32 s34, 40, s34
    s_cselect_b32 s35, 8, s35
    s_mul_i32 s36, s19, 160
    v_mul_u32_u24 v6, s34, v6
    v_add_u32 v6, s36, v6
    v_and_b32 v7, 1, v2
    v_lshlrev_b32 v7, 5, v7
    v_xor_b32 v8, v6, v7
    v_add_u32 v113, v5, v8
    v_add_u32 v6, s35, v6
    v_xor_b32 v8, v6, v7
    v_add_u32 v114, v5, v8
    v_add_u32 v6, s35, v6
    v_xor_b32 v8, v6, v7
    v_add_u32 v115, v5, v8
    v_add_u32 v6, s35, v6
    v_xor_b32 v8, v6, v7
    v_add_u32 v116, v5, v8
    v_add_u32 v6, s35, v6
    v_xor_b32 v8, v6, v7
    v_add_u32 v117, v5, v8
    s_mov_b32 s48, 0
    s_mov_b32 s49, 0
    s_lshl_b32 s3, s15, 1
    s_add_u32 s3, s3, s19
    s_cmp_eq_u32 s3, 28
    s_cselect_b32 s48, 0x00010001, s48
    s_cselect_b32 s49, 0x00010001, s49
    v_mov_b32 v118, 0xbf803f80
    v_mov_b32 v128, 0
    v_mov_b32 v129, 0
    v_mov_b32 v130, 0
    v_mov_b32 v131, 0
    v_mov_b32 v132, 0
    v_mov_b32 v133, 0
    v_mov_b32 v134, 0
    v_mov_b32 v135, 0
    v_mov_b32 v136, 0
    v_mov_b32 v137, 0
    v_mov_b32 v138, 0
    v_mov_b32 v139, 0
    v_mov_b32 v140, 0
    v_mov_b32 v141, 0
    v_mov_b32 v142, 0
    v_mov_b32 v143, 0
    v_mov_b32 v144, 0
    v_mov_b32 v145, 0
    v_mov_b32 v146, 0
    v_mov_b32 v147, 0
    v_mov_b32 v148, 0
    v_mov_b32 v149, 0
    v_mov_b32 v150, 0
    v_mov_b32 v151, 0
    v_mov_b32 v152, 0
    v_mov_b32 v153, 0
    v_mov_b32 v154, 0
    v_mov_b32 v155, 0
    v_mov_b32 v156, 0
    v_mov_b32 v157, 0
    v_mov_b32 v158, 0
    v_mov_b32 v159, 0
    v_mov_b32 v160, 0
    v_mov_b32 v161, 0
    v_mov_b32 v162, 0
    v_mov_b32 v163, 0
    v_mov_b32 v164, 0
    v_mov_b32 v165, 0
    v_mov_b32 v166, 0
    v_mov_b32 v167, 0
    v_mov_b32 v168, 0
    v_mov_b32 v169, 0
    v_mov_b32 v170, 0
    v_mov_b32 v171, 0
    v_mov_b32 v172, 0
    v_mov_b32 v173, 0
    v_mov_b32 v174, 0
    v_mov_b32 v175, 0
    v_mov_b32 v176, 0
    v_mov_b32 v177, 0
    v_mov_b32 v178, 0
    v_mov_b32 v179, 0
    v_mov_b32 v180, 0
    v_mov_b32 v181, 0
    v_mov_b32 v182, 0
    v_mov_b32 v183, 0
    v_mov_b32 v184, 0
    v_mov_b32 v185, 0
    v_mov_b32 v186, 0
    v_mov_b32 v187, 0
    v_mov_b32 v188, 0
    v_mov_b32 v189, 0
    v_mov_b32 v190, 0
    v_mov_b32 v191, 0
    v_mov_b32 v192, 0
    v_mov_b32 v193, 0
    v_mov_b32 v194, 0
    v_mov_b32 v195, 0
    v_mov_b32 v196, 0
    v_mov_b32 v197, 0
    v_mov_b32 v198, 0
    v_mov_b32 v199, 0
    v_mov_b32 v200, 0
    v_mov_b32 v201, 0
    v_mov_b32 v202, 0
    v_mov_b32 v203, 0
    v_mov_b32 v204, 0
    v_mov_b32 v205, 0
    v_mov_b32 v206, 0
    v_mov_b32 v207, 0
    v_mov_b32 v104, v111
    v_mov_b32 v105, v112
    v_mov_b32 v106, v113
    v_mov_b32 v107, v114
    v_mov_b32 v108, v115
    v_mov_b32 v109, v116
    v_mov_b32 v110, v117
    s_waitcnt lgkmcnt(0)
    s_mov_b32 s28, s12
    s_mov_b32 s29, s13
    s_mov_b32 s30, 268435456
    s_mov_b32 s31, 0x20000
    s_mov_b32 s45, 0
    s_mov_b32 s46, 0
    s_barrier
    ds_read_b128 v[32:35], v104 offset:0
    ds_read_b128 v[36:39], v104 offset:2048
    ds_read_b128 v[40:43], v104 offset:4096
    ds_read_b128 v[44:47], v104 offset:6144
    ds_read_b64_tr_b16 v[52:53], v107 offset:0
    ds_read_b64_tr_b16 v[54:55], v107 offset:1280
    ds_read_b64_tr_b16 v[56:57], v108 offset:0
    ds_read_b64_tr_b16 v[58:59], v108 offset:1280
    ds_read_b64_tr_b16 v[60:61], v109 offset:0
    ds_read_b64_tr_b16 v[62:63], v109 offset:1280
    ds_read_b64_tr_b16 v[64:65], v110 offset:0
    ds_read_b64_tr_b16 v[66:67], v110 offset:1280
    ds_read_b64_tr_b16 v[48:49], v106 offset:0
    ds_read_b64_tr_b16 v[50:51], v106 offset:1280
    s_cmp_lt_u32 s17, 2
    s_cbranch_scc0 K1_B_vf
    s_branch K1_B_qk
K1_loop_qk:
    s_waitcnt lgkmcnt(8)
    v_mfma_f32_16x16x32_bf16 v[132:135], v[88:91], v[68:71], v[132:135]
    v_mfma_f32_16x16x32_bf16 v[152:155], v[88:91], v[72:75], v[152:155]
    s_waitcnt lgkmcnt(0)
    s_barrier
    ds_read_b128 v[32:35], v104 offset:0
    v_mfma_f32_16x16x32_bf16 v[172:175], v[88:91], v[76:79], v[172:175]
    ds_read_b128 v[36:39], v104 offset:2048
    v_mfma_f32_16x16x32_bf16 v[192:195], v[88:91], v[80:83], v[192:195]
    ds_read_b128 v[40:43], v104 offset:4096
    v_mfma_f32_16x16x32_bf16 v[136:139], v[92:95], v[68:71], v[136:139]
    ds_read_b128 v[44:47], v104 offset:6144
    v_mfma_f32_16x16x32_bf16 v[156:159], v[92:95], v[72:75], v[156:159]
    ds_read_b64_tr_b16 v[52:53], v107 offset:0
    v_mfma_f32_16x16x32_bf16 v[176:179], v[92:95], v[76:79], v[176:179]
    ds_read_b64_tr_b16 v[54:55], v107 offset:1280
    v_mfma_f32_16x16x32_bf16 v[196:199], v[92:95], v[80:83], v[196:199]
    ds_read_b64_tr_b16 v[56:57], v108 offset:0
    v_mfma_f32_16x16x32_bf16 v[140:143], v[96:99], v[68:71], v[140:143]
    ds_read_b64_tr_b16 v[58:59], v108 offset:1280
    v_mfma_f32_16x16x32_bf16 v[160:163], v[96:99], v[72:75], v[160:163]
    ds_read_b64_tr_b16 v[60:61], v109 offset:0
    v_mfma_f32_16x16x32_bf16 v[180:183], v[96:99], v[76:79], v[180:183]
    ds_read_b64_tr_b16 v[62:63], v109 offset:1280
    v_mfma_f32_16x16x32_bf16 v[200:203], v[96:99], v[80:83], v[200:203]
    ds_read_b64_tr_b16 v[64:65], v110 offset:0
    v_mfma_f32_16x16x32_bf16 v[144:147], v[100:103], v[68:71], v[144:147]
    ds_read_b64_tr_b16 v[66:67], v110 offset:1280
    v_mfma_f32_16x16x32_bf16 v[164:167], v[100:103], v[72:75], v[164:167]
    ds_read_b64_tr_b16 v[48:49], v106 offset:0
    v_mfma_f32_16x16x32_bf16 v[184:187], v[100:103], v[76:79], v[184:187]
    ds_read_b64_tr_b16 v[50:51], v106 offset:1280
    v_mfma_f32_16x16x32_bf16 v[204:207], v[100:103], v[80:83], v[204:207]
    v_mfma_f32_16x16x32_bf16 v[128:131], v[84:87], v[68:71], v[128:131]
    v_mfma_f32_16x16x32_bf16 v[148:151], v[84:87], v[72:75], v[148:151]
    v_mfma_f32_16x16x32_bf16 v[168:171], v[84:87], v[76:79], v[168:171]
    v_mfma_f32_16x16x32_bf16 v[188:191], v[84:87], v[80:83], v[188:191]
    s_cmp_eq_u32 s46, 10
    s_cbranch_scc1 K1_done
K1_B_qk:
    s_waitcnt lgkmcnt(8)
    v_mfma_f32_16x16x32_bf16 v[132:135], v[52:55], v[32:35], v[132:135]
    ds_read_b128 v[68:71], v105 offset:0
    v_mfma_f32_16x16x32_bf16 v[152:155], v[52:55], v[36:39], v[152:155]
    ds_read_b128 v[72:75], v105 offset:2048
    v_mfma_f32_16x16x32_bf16 v[172:175], v[52:55], v[40:43], v[172:175]
    ds_read_b128 v[76:79], v105 offset:4096
    v_mfma_f32_16x16x32_bf16 v[192:195], v[52:55], v[44:47], v[192:195]
    ds_read_b128 v[80:83], v105 offset:6144
    s_waitcnt lgkmcnt(10)
    v_mfma_f32_16x16x32_bf16 v[136:139], v[56:59], v[32:35], v[136:139]
    ds_read_b64_tr_b16 v[88:89], v107 offset:10240
    v_mfma_f32_16x16x32_bf16 v[156:159], v[56:59], v[36:39], v[156:159]
    ds_read_b64_tr_b16 v[90:91], v107 offset:11520
    v_mfma_f32_16x16x32_bf16 v[176:179], v[56:59], v[40:43], v[176:179]
    ds_read_b64_tr_b16 v[92:93], v108 offset:10240
    v_mfma_f32_16x16x32_bf16 v[196:199], v[56:59], v[44:47], v[196:199]
    ds_read_b64_tr_b16 v[94:95], v108 offset:11520
    s_waitcnt lgkmcnt(12)
    v_mfma_f32_16x16x32_bf16 v[140:143], v[60:63], v[32:35], v[140:143]
    ds_read_b64_tr_b16 v[96:97], v109 offset:10240
    v_mfma_f32_16x16x32_bf16 v[160:163], v[60:63], v[36:39], v[160:163]
    ds_read_b64_tr_b16 v[98:99], v109 offset:11520
    s_waitcnt lgkmcnt(10)
    v_mfma_f32_16x16x32_bf16 v[180:183], v[60:63], v[40:43], v[180:183]
    ds_read_b64_tr_b16 v[100:101], v110 offset:10240
    v_mfma_f32_16x16x32_bf16 v[200:203], v[60:63], v[44:47], v[200:203]
    ds_read_b64_tr_b16 v[102:103], v110 offset:11520
    v_mfma_f32_16x16x32_bf16 v[144:147], v[64:67], v[32:35], v[144:147]
    ds_read_b64_tr_b16 v[84:85], v106 offset:10240
    v_mfma_f32_16x16x32_bf16 v[164:167], v[64:67], v[36:39], v[164:167]
    ds_read_b64_tr_b16 v[86:87], v106 offset:11520
    s_add_u32 s45, s45, 36864
    s_cmp_eq_u32 s45, 147456
    s_cselect_b32 s45, 0, s45
    v_mfma_f32_16x16x32_bf16 v[184:187], v[64:67], v[40:43], v[184:187]
    v_add_u32 v104, s45, v111
    v_add_u32 v105, s45, v112
    v_add_u32 v106, s45, v113
    v_mfma_f32_16x16x32_bf16 v[204:207], v[64:67], v[44:47], v[204:207]
    v_add_u32 v107, s45, v114
    v_add_u32 v108, s45, v115
    v_add_u32 v109, s45, v116
    v_mfma_f32_16x16x32_bf16 v[128:131], v[48:51], v[32:35], v[128:131]
    v_add_u32 v110, s45, v117
    s_add_u32 s46, s46, 1
    v_mfma_f32_16x16x32_bf16 v[148:151], v[48:51], v[36:39], v[148:151]
    v_mfma_f32_16x16x32_bf16 v[168:171], v[48:51], v[40:43], v[168:171]
    v_mfma_f32_16x16x32_bf16 v[188:191], v[48:51], v[44:47], v[188:191]
    s_branch K1_loop_qk
K1_loop_vf:
    s_waitcnt lgkmcnt(8)
    v_mfma_f32_16x16x32_bf16 v[132:135], v[68:71], v[88:91], v[132:135]
    v_mfma_f32_16x16x32_bf16 v[152:155], v[72:75], v[88:91], v[152:155]
    s_waitcnt lgkmcnt(0)
    s_barrier
    ds_read_b128 v[32:35], v104 offset:0
    v_mfma_f32_16x16x32_bf16 v[172:175], v[76:79], v[88:91], v[172:175]
    ds_read_b128 v[36:39], v104 offset:2048
    v_mfma_f32_16x16x32_bf16 v[192:195], v[80:83], v[88:91], v[192:195]
    ds_read_b128 v[40:43], v104 offset:4096
    v_mfma_f32_16x16x32_bf16 v[136:139], v[68:71], v[92:95], v[136:139]
    ds_read_b128 v[44:47], v104 offset:6144
    v_mfma_f32_16x16x32_bf16 v[156:159], v[72:75], v[92:95], v[156:159]
    ds_read_b64_tr_b16 v[52:53], v107 offset:0
    v_mfma_f32_16x16x32_bf16 v[176:179], v[76:79], v[92:95], v[176:179]
    ds_read_b64_tr_b16 v[54:55], v107 offset:1280
    v_mfma_f32_16x16x32_bf16 v[196:199], v[80:83], v[92:95], v[196:199]
    ds_read_b64_tr_b16 v[56:57], v108 offset:0
    v_mfma_f32_16x16x32_bf16 v[140:143], v[68:71], v[96:99], v[140:143]
    ds_read_b64_tr_b16 v[58:59], v108 offset:1280
    v_mfma_f32_16x16x32_bf16 v[160:163], v[72:75], v[96:99], v[160:163]
    ds_read_b64_tr_b16 v[60:61], v109 offset:0
    v_mfma_f32_16x16x32_bf16 v[180:183], v[76:79], v[96:99], v[180:183]
    ds_read_b64_tr_b16 v[62:63], v109 offset:1280
    v_cndmask_b32 v84, v84, v118, s[48:49]
    v_mfma_f32_16x16x32_bf16 v[200:203], v[80:83], v[96:99], v[200:203]
    ds_read_b64_tr_b16 v[64:65], v110 offset:0
    v_cndmask_b32 v85, v85, v118, s[48:49]
    v_mfma_f32_16x16x32_bf16 v[144:147], v[68:71], v[100:103], v[144:147]
    ds_read_b64_tr_b16 v[66:67], v110 offset:1280
    v_cndmask_b32 v86, v86, v118, s[48:49]
    v_mfma_f32_16x16x32_bf16 v[164:167], v[72:75], v[100:103], v[164:167]
    ds_read_b64_tr_b16 v[48:49], v106 offset:0
    v_cndmask_b32 v87, v87, v118, s[48:49]
    v_mfma_f32_16x16x32_bf16 v[184:187], v[76:79], v[100:103], v[184:187]
    ds_read_b64_tr_b16 v[50:51], v106 offset:1280
    v_mfma_f32_16x16x32_bf16 v[204:207], v[80:83], v[100:103], v[204:207]
    v_mfma_f32_16x16x32_bf16 v[128:131], v[68:71], v[84:87], v[128:131]
    v_mfma_f32_16x16x32_bf16 v[148:151], v[72:75], v[84:87], v[148:151]
    v_mfma_f32_16x16x32_bf16 v[168:171], v[76:79], v[84:87], v[168:171]
    v_mfma_f32_16x16x32_bf16 v[188:191], v[80:83], v[84:87], v[188:191]
    s_cmp_eq_u32 s46, 10
    s_cbranch_scc1 K1_done
K1_B_vf:
    s_waitcnt lgkmcnt(8)
    v_mfma_f32_16x16x32_bf16 v[132:135], v[32:35], v[52:55], v[132:135]
    ds_read_b128 v[68:71], v105 offset:0
    v_mfma_f32_16x16x32_bf16 v[152:155], v[36:39], v[52:55], v[152:155]
    ds_read_b128 v[72:75], v105 offset:2048
    v_mfma_f32_16x16x32_bf16 v[172:175], v[40:43], v[52:55], v[172:175]
    ds_read_b128 v[76:79], v105 offset:4096
    v_mfma_f32_16x16x32_bf16 v[192:195], v[44:47], v[52:55], v[192:195]
    ds_read_b128 v[80:83], v105 offset:6144
    s_waitcnt lgkmcnt(10)
    v_mfma_f32_16x16x32_bf16 v[136:139], v[32:35], v[56:59], v[136:139]
    ds_read_b64_tr_b16 v[88:89], v107 offset:10240
    v_mfma_f32_16x16x32_bf16 v[156:159], v[36:39], v[56:59], v[156:159]
    ds_read_b64_tr_b16 v[90:91], v107 offset:11520
    v_mfma_f32_16x16x32_bf16 v[176:179], v[40:43], v[56:59], v[176:179]
    ds_read_b64_tr_b16 v[92:93], v108 offset:10240
    v_mfma_f32_16x16x32_bf16 v[196:199], v[44:47], v[56:59], v[196:199]
    ds_read_b64_tr_b16 v[94:95], v108 offset:11520
    s_waitcnt lgkmcnt(12)
    v_mfma_f32_16x16x32_bf16 v[140:143], v[32:35], v[60:63], v[140:143]
    ds_read_b64_tr_b16 v[96:97], v109 offset:10240
    v_mfma_f32_16x16x32_bf16 v[160:163], v[36:39], v[60:63], v[160:163]
    ds_read_b64_tr_b16 v[98:99], v109 offset:11520
    s_waitcnt lgkmcnt(10)
    v_mfma_f32_16x16x32_bf16 v[180:183], v[40:43], v[60:63], v[180:183]
    ds_read_b64_tr_b16 v[100:101], v110 offset:10240
    v_cndmask_b32 v48, v48, v118, s[48:49]
    v_mfma_f32_16x16x32_bf16 v[200:203], v[44:47], v[60:63], v[200:203]
    ds_read_b64_tr_b16 v[102:103], v110 offset:11520
    v_cndmask_b32 v49, v49, v118, s[48:49]
    v_mfma_f32_16x16x32_bf16 v[144:147], v[32:35], v[64:67], v[144:147]
    ds_read_b64_tr_b16 v[84:85], v106 offset:10240
    v_cndmask_b32 v50, v50, v118, s[48:49]
    v_mfma_f32_16x16x32_bf16 v[164:167], v[36:39], v[64:67], v[164:167]
    ds_read_b64_tr_b16 v[86:87], v106 offset:11520
    v_cndmask_b32 v51, v51, v118, s[48:49]
    s_add_u32 s45, s45, 36864
    s_cmp_eq_u32 s45, 147456
    s_cselect_b32 s45, 0, s45
    v_mfma_f32_16x16x32_bf16 v[184:187], v[40:43], v[64:67], v[184:187]
    v_add_u32 v104, s45, v111
    v_add_u32 v105, s45, v112
    v_add_u32 v106, s45, v113
    v_mfma_f32_16x16x32_bf16 v[204:207], v[44:47], v[64:67], v[204:207]
    v_add_u32 v107, s45, v114
    v_add_u32 v108, s45, v115
    v_add_u32 v109, s45, v116
    v_mfma_f32_16x16x32_bf16 v[128:131], v[32:35], v[48:51], v[128:131]
    v_add_u32 v110, s45, v117
    s_add_u32 s46, s46, 1
    v_mfma_f32_16x16x32_bf16 v[148:151], v[36:39], v[48:51], v[148:151]
    v_mfma_f32_16x16x32_bf16 v[168:171], v[40:43], v[48:51], v[168:171]
    v_mfma_f32_16x16x32_bf16 v[188:191], v[44:47], v[48:51], v[188:191]
    s_branch K1_loop_vf
K1_done:
    s_waitcnt lgkmcnt(0)
    v_and_b32 v1, 15, v0
    v_lshrrev_b32 v2, 4, v0
    s_cmp_eq_u32 s17, 2
    s_cbranch_scc1 K1_epV
    s_cmp_eq_u32 s17, 3
    s_cbranch_scc1 K1_epF
    s_mov_b32 s34, 81920
    s_mov_b32 s35, 5120
    s_mov_b32 s36, 0
    s_cmp_eq_u32 s17, 1
    s_cselect_b32 s34, 167936, s34
    s_cselect_b32 s35, 10496, s35
    s_cselect_b32 s36, 2621440, s36
    s_cbranch_scc1 K1_noscale
    s_mov_b32 s38, 1051011932
    s_mov_b32 s39, 1051011932
    v_pk_mul_f32 v[128:129], v[128:129], s[38:39]
    v_pk_mul_f32 v[130:131], v[130:131], s[38:39]
    v_pk_mul_f32 v[132:133], v[132:133], s[38:39]
    v_pk_mul_f32 v[134:135], v[134:135], s[38:39]
    v_pk_mul_f32 v[136:137], v[136:137], s[38:39]
    v_pk_mul_f32 v[138:139], v[138:139], s[38:39]
    v_pk_mul_f32 v[140:141], v[140:141], s[38:39]
    v_pk_mul_f32 v[142:143], v[142:143], s[38:39]
    v_pk_mul_f32 v[144:145], v[144:145], s[38:39]
    v_pk_mul_f32 v[146:147], v[146:147], s[38:39]
    v_pk_mul_f32 v[148:149], v[148:149], s[38:39]
    v_pk_mul_f32 v[150:151], v[150:151], s[38:39]
    v_pk_mul_f32 v[152:153], v[152:153], s[38:39]
    v_pk_mul_f32 v[154:155], v[154:155], s[38:39]
    v_pk_mul_f32 v[156:157], v[156:157], s[38:39]
    v_pk_mul_f32 v[158:159], v[158:159], s[38:39]
    v_pk_mul_f32 v[160:161], v[160:161], s[38:39]
    v_pk_mul_f32 v[162:163], v[162:163], s[38:39]
    v_pk_mul_f32 v[164:165], v[164:165], s[38:39]
    v_pk_mul_f32 v[166:167], v[166:167], s[38:39]
    v_pk_mul_f32 v[168:169], v[168:169], s[38:39]
    v_pk_mul_f32 v[170:171], v[170:171], s[38:39]
    v_pk_mul_f32 v[172:173], v[172:173], s[38:39]
    v_pk_mul_f32 v[174:175], v[174:175], s[38:39]
    v_pk_mul_f32 v[176:177], v[176:177], s[38:39]
    v_pk_mul_f32 v[178:179], v[178:179], s[38:39]
    v_pk_mul_f32 v[180:181], v[180:181], s[38:39]
    v_pk_mul_f32 v[182:183], v[182:183], s[38:39]
    v_pk_mul_f32 v[184:185], v[184:185], s[38:39]
    v_pk_mul_f32 v[186:187], v[186:187], s[38:39]
    v_pk_mul_f32 v[188:189], v[188:189], s[38:39]
    v_pk_mul_f32 v[190:191], v[190:191], s[38:39]
    v_pk_mul_f32 v[192:193], v[192:193], s[38:39]
    v_pk_mul_f32 v[194:195], v[194:195], s[38:39]
    v_pk_mul_f32 v[196:197], v[196:197], s[38:39]
    v_pk_mul_f32 v[198:199], v[198:199], s[38:39]
    v_pk_mul_f32 v[200:201], v[200:201], s[38:39]
    v_pk_mul_f32 v[202:203], v[202:203], s[38:39]
    v_pk_mul_f32 v[204:205], v[204:205], s[38:39]
    v_pk_mul_f32 v[206:207], v[206:207], s[38:39]
K1_noscale:
    s_and_b32 s3, s15, 3
    s_lshl_b32 s3, s3, 1
    s_add_u32 s3, s3, s19
    s_lshl_b32 s3, s3, 2
    s_mul_i32 s3, s3, s34
    s_add_u32 s36, s36, s3
    s_mul_i32 s3, s14, s35
    s_add_u32 s36, s36, s3
    s_lshl_b32 s3, s18, 11
    s_add_u32 s37, s36, s3
    s_lshl_b32 s3, s18, 9
    s_add_u32 s38, s36, s3
    s_add_u32 s38, s38, 4096
    v_mul_lo_u32 v3, v2, s34
    v_lshl_add_u32 v3, v1, 4, v3
    s_and_b32 s3, s14, 7
    s_mul_i32 s3, s17, s3
    s_cmp_ge_u32 s3, 4
    s_cbranch_scc1 K1_epK_nt
    v_cvt_pk_bf16_f32 v32, v128, v129
    v_cvt_pk_bf16_f32 v33, v130, v131
    v_cvt_pk_bf16_f32 v34, v132, v133
    v_cvt_pk_bf16_f32 v35, v134, v135
    buffer_store_dwordx4 v[32:35], v3, s[28:31], s37 offen offset:0
    v_cvt_pk_bf16_f32 v36, v136, v137
    v_cvt_pk_bf16_f32 v37, v138, v139
    v_cvt_pk_bf16_f32 v38, v140, v141
    v_cvt_pk_bf16_f32 v39, v142, v143
    buffer_store_dwordx4 v[36:39], v3, s[28:31], s37 offen offset:512
    v_cvt_pk_bf16_f32 v40, v148, v149
    v_cvt_pk_bf16_f32 v41, v150, v151
    v_cvt_pk_bf16_f32 v42, v152, v153
    v_cvt_pk_bf16_f32 v43, v154, v155
    buffer_store_dwordx4 v[40:43], v3, s[28:31], s37 offen offset:256
    v_cvt_pk_bf16_f32 v44, v156, v157
    v_cvt_pk_bf16_f32 v45, v158, v159
    v_cvt_pk_bf16_f32 v46, v160, v161
    v_cvt_pk_bf16_f32 v47, v162, v163
    buffer_store_dwordx4 v[44:47], v3, s[28:31], s37 offen offset:768
    v_cvt_pk_bf16_f32 v48, v168, v169
    v_cvt_pk_bf16_f32 v49, v170, v171
    v_cvt_pk_bf16_f32 v50, v172, v173
    v_cvt_pk_bf16_f32 v51, v174, v175
    buffer_store_dwordx4 v[48:51], v3, s[28:31], s37 offen offset:1024
    v_cvt_pk_bf16_f32 v52, v176, v177
    v_cvt_pk_bf16_f32 v53, v178, v179
    v_cvt_pk_bf16_f32 v54, v180, v181
    v_cvt_pk_bf16_f32 v55, v182, v183
    buffer_store_dwordx4 v[52:55], v3, s[28:31], s37 offen offset:1536
    v_cvt_pk_bf16_f32 v56, v188, v189
    v_cvt_pk_bf16_f32 v57, v190, v191
    v_cvt_pk_bf16_f32 v58, v192, v193
    v_cvt_pk_bf16_f32 v59, v194, v195
    buffer_store_dwordx4 v[56:59], v3, s[28:31], s37 offen offset:1280
    v_cvt_pk_bf16_f32 v60, v196, v197
    v_cvt_pk_bf16_f32 v61, v198, v199
    v_cvt_pk_bf16_f32 v62, v200, v201
    v_cvt_pk_bf16_f32 v63, v202, v203
    buffer_store_dwordx4 v[60:63], v3, s[28:31], s37 offen offset:1792
    v_cvt_pk_bf16_f32 v64, v144, v145
    v_cvt_pk_bf16_f32 v65, v146, v147
    v_cvt_pk_bf16_f32 v66, v184, v185
    v_cvt_pk_bf16_f32 v67, v186, v187
    buffer_store_dwordx4 v[64:67], v3, s[28:31], s38 offen offset:0
    v_cvt_pk_bf16_f32 v68, v164, v165
    v_cvt_pk_bf16_f32 v69, v166, v167
    v_cvt_pk_bf16_f32 v70, v204, v205
    v_cvt_pk_bf16_f32 v71, v206, v207
    buffer_store_dwordx4 v[68:71], v3, s[28:31], s38 offen offset:256
    s_endpgm
K1_epK_nt:
    v_cvt_pk_bf16_f32 v32, v128, v129
    v_cvt_pk_bf16_f32 v33, v130, v131
    v_cvt_pk_bf16_f32 v34, v132, v133
    v_cvt_pk_bf16_f32 v35, v134, v135
    buffer_store_dwordx4 v[32:35], v3, s[28:31], s37 offen offset:0 nt
    v_cvt_pk_bf16_f32 v36, v136, v137
    v_cvt_pk_bf16_f32 v37, v138, v139
    v_cvt_pk_bf16_f32 v38, v140, v141
    v_cvt_pk_bf16_f32 v39, v142, v143
    buffer_store_dwordx4 v[36:39], v3, s[28:31], s37 offen offset:512 nt
    v_cvt_pk_bf16_f32 v40, v148, v149
    v_cvt_pk_bf16_f32 v41, v150, v151
    v_cvt_pk_bf16_f32 v42, v152, v153
    v_cvt_pk_bf16_f32 v43, v154, v155
    buffer_store_dwordx4 v[40:43], v3, s[28:31], s37 offen offset:256 nt
    v_cvt_pk_bf16_f32 v44, v156, v157
    v_cvt_pk_bf16_f32 v45, v158, v159
    v_cvt_pk_bf16_f32 v46, v160, v161
    v_cvt_pk_bf16_f32 v47, v162, v163
    buffer_store_dwordx4 v[44:47], v3, s[28:31], s37 offen offset:768 nt
    v_cvt_pk_bf16_f32 v48, v168, v169
    v_cvt_pk_bf16_f32 v49, v170, v171
    v_cvt_pk_bf16_f32 v50, v172, v173
    v_cvt_pk_bf16_f32 v51, v174, v175
    buffer_store_dwordx4 v[48:51], v3, s[28:31], s37 offen offset:1024 nt
    v_cvt_pk_bf16_f32 v52, v176, v177
    v_cvt_pk_bf16_f32 v53, v178, v179
    v_cvt_pk_bf16_f32 v54, v180, v181
    v_cvt_pk_bf16_f32 v55, v182, v183
    buffer_store_dwordx4 v[52:55], v3, s[28:31], s37 offen offset:1536 nt
    v_cvt_pk_bf16_f32 v56, v188, v189
    v_cvt_pk_bf16_f32 v57, v190, v191
    v_cvt_pk_bf16_f32 v58, v192, v193
    v_cvt_pk_bf16_f32 v59, v194, v195
    buffer_store_dwordx4 v[56:59], v3, s[28:31], s37 offen offset:1280 nt
    v_cvt_pk_bf16_f32 v60, v196, v197
    v_cvt_pk_bf16_f32 v61, v198, v199
    v_cvt_pk_bf16_f32 v62, v200, v201
    v_cvt_pk_bf16_f32 v63, v202, v203
    buffer_store_dwordx4 v[60:63], v3, s[28:31], s37 offen offset:1792 nt
    v_cvt_pk_bf16_f32 v64, v144, v145
    v_cvt_pk_bf16_f32 v65, v146, v147
    v_cvt_pk_bf16_f32 v66, v184, v185
    v_cvt_pk_bf16_f32 v67, v186, v187
    buffer_store_dwordx4 v[64:67], v3, s[28:31], s38 offen offset:0 nt
    v_cvt_pk_bf16_f32 v68, v164, v165
    v_cvt_pk_bf16_f32 v69, v166, v167
    v_cvt_pk_bf16_f32 v70, v204, v205
    v_cvt_pk_bf16_f32 v71, v206, v207
    buffer_store_dwordx4 v[68:71], v3, s[28:31], s38 offen offset:256 nt
    s_endpgm
K1_epV:
    s_and_b32 s3, s15, 3
    s_lshl_b32 s3, s3, 1
    s_add_u32 s3, s3, s19
    s_mul_i32 s36, s3, 671744
    s_mul_i32 s3, s14, 10496
    s_add_u32 s36, s36, s3
    s_mul_i32 s3, s18, 2688
    s_add_u32 s36, s36, s3
    s_add_u32 s36, s36, 2626560
    s_mov_b32 s34, 167616
    v_mul_u32_u24 v3, 336, v2
    v_and_b32 v4, 3, v0
    s_mov_b32 s35, 167936
    v_mul_lo_u32 v4, v4, s35
    v_bfe_u32 v5, v0, 2, 3
    v_mul_u32_u24 v5, 336, v5
    v_add3_u32 v4, v4, v5, 0
    v_mov_b32 v16, 0x3f803f80
    v_mov_b32 v17, 0x3f803f80
    v_mov_b32 v18, 0x3f803f80
    v_mov_b32 v19, 0x3f803f80
    buffer_store_dwordx4 v[16:19], v4, s[28:31], s36 offen offset:320
    s_and_b32 s3, s14, 7
    s_cmp_ge_u32 s3, 4
    s_cbranch_scc1 K1_epV_nt
    v_add_u32 v4, 0, v1
    v_mul_u32_u24 v5, 3277, v4
    v_lshrrev_b32 v5, 16, v5
    v_lshl_add_u32 v4, v4, 4, v3
    v_mul_lo_u32 v5, v5, s34
    v_add_u32 v8, v4, v5
    v_cvt_pk_bf16_f32 v32, v128, v129
    v_cvt_pk_bf16_f32 v33, v130, v131
    v_cvt_pk_bf16_f32 v34, v148, v149
    v_cvt_pk_bf16_f32 v35, v150, v151
    buffer_store_dwordx4 v[32:35], v8, s[28:31], s36 offen offset:0
    v_cvt_pk_bf16_f32 v36, v168, v169
    v_cvt_pk_bf16_f32 v37, v170, v171
    v_cvt_pk_bf16_f32 v38, v188, v189
    v_cvt_pk_bf16_f32 v39, v190, v191
    buffer_store_dwordx4 v[36:39], v8, s[28:31], s36 offen offset:1344
    v_add_u32 v4, 16, v1
    v_mul_u32_u24 v5, 3277, v4
    v_lshrrev_b32 v5, 16, v5
    v_lshl_add_u32 v4, v4, 4, v3
    v_mul_lo_u32 v5, v5, s34
    v_add_u32 v9, v4, v5
    v_cvt_pk_bf16_f32 v40, v132, v133
    v_cvt_pk_bf16_f32 v41, v134, v135
    v_cvt_pk_bf16_f32 v42, v152, v153
    v_cvt_pk_bf16_f32 v43, v154, v155
    buffer_store_dwordx4 v[40:43], v9, s[28:31], s36 offen offset:0
    v_cvt_pk_bf16_f32 v44, v172, v173
    v_cvt_pk_bf16_f32 v45, v174, v175
    v_cvt_pk_bf16_f32 v46, v192, v193
    v_cvt_pk_bf16_f32 v47, v194, v195
    buffer_store_dwordx4 v[44:47], v9, s[28:31], s36 offen offset:1344
    v_add_u32 v4, 32, v1
    v_mul_u32_u24 v5, 3277, v4
    v_lshrrev_b32 v5, 16, v5
    v_lshl_add_u32 v4, v4, 4, v3
    v_mul_lo_u32 v5, v5, s34
    v_add_u32 v10, v4, v5
    v_cvt_pk_bf16_f32 v48, v136, v137
    v_cvt_pk_bf16_f32 v49, v138, v139
    v_cvt_pk_bf16_f32 v50, v156, v157
    v_cvt_pk_bf16_f32 v51, v158, v159
    buffer_store_dwordx4 v[48:51], v10, s[28:31], s36 offen offset:0
    v_cvt_pk_bf16_f32 v52, v176, v177
    v_cvt_pk_bf16_f32 v53, v178, v179
    v_cvt_pk_bf16_f32 v54, v196, v197
    v_cvt_pk_bf16_f32 v55, v198, v199
    buffer_store_dwordx4 v[52:55], v10, s[28:31], s36 offen offset:1344
    v_add_u32 v4, 48, v1
    v_mul_u32_u24 v5, 3277, v4
    v_lshrrev_b32 v5, 16, v5
    v_lshl_add_u32 v4, v4, 4, v3
    v_mul_lo_u32 v5, v5, s34
    v_add_u32 v11, v4, v5
    v_cvt_pk_bf16_f32 v56, v140, v141
    v_cvt_pk_bf16_f32 v57, v142, v143
    v_cvt_pk_bf16_f32 v58, v160, v161
    v_cvt_pk_bf16_f32 v59, v162, v163
    buffer_store_dwordx4 v[56:59], v11, s[28:31], s36 offen offset:0
    v_cvt_pk_bf16_f32 v60, v180, v181
    v_cvt_pk_bf16_f32 v61, v182, v183
    v_cvt_pk_bf16_f32 v62, v200, v201
    v_cvt_pk_bf16_f32 v63, v202, v203
    buffer_store_dwordx4 v[60:63], v11, s[28:31], s36 offen offset:1344
    v_add_u32 v4, 64, v1
    v_mul_u32_u24 v5, 3277, v4
    v_lshrrev_b32 v5, 16, v5
    v_lshl_add_u32 v4, v4, 4, v3
    v_mul_lo_u32 v5, v5, s34
    v_add_u32 v12, v4, v5
    v_cvt_pk_bf16_f32 v64, v144, v145
    v_cvt_pk_bf16_f32 v65, v146, v147
    v_cvt_pk_bf16_f32 v66, v164, v165
    v_cvt_pk_bf16_f32 v67, v166, v167
    buffer_store_dwordx4 v[64:67], v12, s[28:31], s36 offen offset:0
    v_cvt_pk_bf16_f32 v68, v184, v185
    v_cvt_pk_bf16_f32 v69, v186, v187
    v_cvt_pk_bf16_f32 v70, v204, v205
    v_cvt_pk_bf16_f32 v71, v206, v207
    buffer_store_dwordx4 v[68:71], v12, s[28:31], s36 offen offset:1344
    s_endpgm
K1_epV_nt:
    v_add_u32 v4, 0, v1
    v_mul_u32_u24 v5, 3277, v4
    v_lshrrev_b32 v5, 16, v5
    v_lshl_add_u32 v4, v4, 4, v3
    v_mul_lo_u32 v5, v5, s34
    v_add_u32 v8, v4, v5
    v_cvt_pk_bf16_f32 v32, v128, v129
    v_cvt_pk_bf16_f32 v33, v130, v131
    v_cvt_pk_bf16_f32 v34, v148, v149
    v_cvt_pk_bf16_f32 v35, v150, v151
    buffer_store_dwordx4 v[32:35], v8, s[28:31], s36 offen offset:0 nt
    v_cvt_pk_bf16_f32 v36, v168, v169
    v_cvt_pk_bf16_f32 v37, v170, v171
    v_cvt_pk_bf16_f32 v38, v188, v189
    v_cvt_pk_bf16_f32 v39, v190, v191
    buffer_store_dwordx4 v[36:39], v8, s[28:31], s36 offen offset:1344 nt
    v_add_u32 v4, 16, v1
    v_mul_u32_u24 v5, 3277, v4
    v_lshrrev_b32 v5, 16, v5
    v_lshl_add_u32 v4, v4, 4, v3
    v_mul_lo_u32 v5, v5, s34
    v_add_u32 v9, v4, v5
    v_cvt_pk_bf16_f32 v40, v132, v133
    v_cvt_pk_bf16_f32 v41, v134, v135
    v_cvt_pk_bf16_f32 v42, v152, v153
    v_cvt_pk_bf16_f32 v43, v154, v155
    buffer_store_dwordx4 v[40:43], v9, s[28:31], s36 offen offset:0 nt
    v_cvt_pk_bf16_f32 v44, v172, v173
    v_cvt_pk_bf16_f32 v45, v174, v175
    v_cvt_pk_bf16_f32 v46, v192, v193
    v_cvt_pk_bf16_f32 v47, v194, v195
    buffer_store_dwordx4 v[44:47], v9, s[28:31], s36 offen offset:1344 nt
    v_add_u32 v4, 32, v1
    v_mul_u32_u24 v5, 3277, v4
    v_lshrrev_b32 v5, 16, v5
    v_lshl_add_u32 v4, v4, 4, v3
    v_mul_lo_u32 v5, v5, s34
    v_add_u32 v10, v4, v5
    v_cvt_pk_bf16_f32 v48, v136, v137
    v_cvt_pk_bf16_f32 v49, v138, v139
    v_cvt_pk_bf16_f32 v50, v156, v157
    v_cvt_pk_bf16_f32 v51, v158, v159
    buffer_store_dwordx4 v[48:51], v10, s[28:31], s36 offen offset:0 nt
    v_cvt_pk_bf16_f32 v52, v176, v177
    v_cvt_pk_bf16_f32 v53, v178, v179
    v_cvt_pk_bf16_f32 v54, v196, v197
    v_cvt_pk_bf16_f32 v55, v198, v199
    buffer_store_dwordx4 v[52:55], v10, s[28:31], s36 offen offset:1344 nt
    v_add_u32 v4, 48, v1
    v_mul_u32_u24 v5, 3277, v4
    v_lshrrev_b32 v5, 16, v5
    v_lshl_add_u32 v4, v4, 4, v3
    v_mul_lo_u32 v5, v5, s34
    v_add_u32 v11, v4, v5
    v_cvt_pk_bf16_f32 v56, v140, v141
    v_cvt_pk_bf16_f32 v57, v142, v143
    v_cvt_pk_bf16_f32 v58, v160, v161
    v_cvt_pk_bf16_f32 v59, v162, v163
    buffer_store_dwordx4 v[56:59], v11, s[28:31], s36 offen offset:0 nt
    v_cvt_pk_bf16_f32 v60, v180, v181
    v_cvt_pk_bf16_f32 v61, v182, v183
    v_cvt_pk_bf16_f32 v62, v200, v201
    v_cvt_pk_bf16_f32 v63, v202, v203
    buffer_store_dwordx4 v[60:63], v11, s[28:31], s36 offen offset:1344 nt
    v_add_u32 v4, 64, v1
    v_mul_u32_u24 v5, 3277, v4
    v_lshrrev_b32 v5, 16, v5
    v_lshl_add_u32 v4, v4, 4, v3
    v_mul_lo_u32 v5, v5, s34
    v_add_u32 v12, v4, v5
    v_cvt_pk_bf16_f32 v64, v144, v145
    v_cvt_pk_bf16_f32 v65, v146, v147
    v_cvt_pk_bf16_f32 v66, v164, v165
    v_cvt_pk_bf16_f32 v67, v166, v167
    buffer_store_dwordx4 v[64:67], v12, s[28:31], s36 offen offset:0 nt
    v_cvt_pk_bf16_f32 v68, v184, v185
    v_cvt_pk_bf16_f32 v69, v186, v187
    v_cvt_pk_bf16_f32 v70, v204, v205
    v_cvt_pk_bf16_f32 v71, v206, v207
    buffer_store_dwordx4 v[68:71], v12, s[28:31], s36 offen offset:1344 nt
    s_endpgm
K1_epF:
    s_and_b32 s3, s15, 1
    s_lshl_b32 s3, s3, 1
    s_add_u32 s3, s3, s19
    s_mul_i32 s34, s3, 80
    s_lshr_b32 s36, s14, 1
    s_lshl_b32 s36, s36, 12
    s_and_b32 s3, s14, 1
    s_lshl_b32 s3, s3, 9
    s_add_u32 s36, s36, s3
    s_lshl_b32 s3, s18, 11
    s_add_u32 s36, s36, s3
    s_add_u32 s36, s36, 7999488
    s_mov_b32 s37, 1.0
    s_mov_b32 s38, 0
    s_mov_b32 s39, 0
    s_cmp_ge_u32 s15, 14
    s_cselect_b32 s37, -1.0, s37
    s_cselect_b32 s38, 720896, s38
    s_cselect_b32 s39, 1408, s39
    s_add_u32 s3, s14, s18
    s_cmp_eq_u32 s3, 0
    s_cselect_b32 s40, 0xffff, 0
    s_mov_b32 s41, 0
    v_lshrrev_b32 v3, 1, v2
    v_lshlrev_b32 v3, 10, v3
    v_and_b32 v16, 1, v2
    s_mov_b32 s3, 360448
    v_mad_u32_u24 v16, v16, s3, v3
    v_add_u32 v3, s38, v16
    v_mov_b32 v4, s37
    v_mov_b32 v5, 1.0
    v_cndmask_b32 v5, v4, v5, s[48:49]
    v_cndmask_b32 v6, v4, 0, s[40:41]
    v_cndmask_b32 v7, v5, 0, s[40:41]
    v_add_u32 v13, s34, v1
    v_add_u32 v14, 0, v13
    v_lshrrev_b32 v15, 5, v14
    v_and_b32 v14, 31, v14
    v_lshl_add_u32 v14, v14, 4, v3
    v_lshl_add_u32 v8, v15, 15, v14
    v_add_u32 v14, 327680, v16
    v_cndmask_b32 v8, v8, v14, s[48:49]
    v_fma_f32 v88, v188, v5, v168
    v_fma_f32 v72, v168, v7, v128
    v_fma_f32 v76, v188, v7, v148
    v_fma_f32 v73, v169, v5, v129
    v_fma_f32 v77, v189, v5, v149
    v_fma_f32 v74, v170, v5, v130
    v_fma_f32 v78, v190, v5, v150
    v_fma_f32 v75, v171, v5, v131
    v_fma_f32 v79, v191, v5, v151
    v_fma_f32 v80, v76, v5, v72
    v_fma_f32 v84, v76, -v5, v72
    v_fma_f32 v81, v77, v5, v73
    v_fma_f32 v85, v77, -v5, v73
    v_fma_f32 v82, v78, v5, v74
    v_fma_f32 v86, v78, -v5, v74
    v_fma_f32 v83, v79, v5, v75
    v_fma_f32 v87, v79, -v5, v75
    v_cvt_pk_bf16_f32 v32, v80, v81
    v_cvt_pk_bf16_f32 v33, v82, v83
    v_cvt_pk_bf16_f32 v34, v84, v85
    v_cvt_pk_bf16_f32 v35, v86, v87
    s_nop 1
    v_permlane16_swap_b32 v32, v34
    v_permlane16_swap_b32 v33, v35
    s_nop 0
    buffer_store_dwordx4 v[32:35], v8, s[28:31], s36 offen nt
    v_add_u32 v14, 16, v13
    v_lshrrev_b32 v15, 5, v14
    v_and_b32 v14, 31, v14
    v_lshl_add_u32 v14, v14, 4, v3
    v_lshl_add_u32 v9, v15, 15, v14
    v_fma_f32 v89, v192, v4, v172
    v_fma_f32 v72, v172, v6, v132
    v_fma_f32 v76, v192, v6, v152
    v_fma_f32 v73, v173, v4, v133
    v_fma_f32 v77, v193, v4, v153
    v_fma_f32 v74, v174, v4, v134
    v_fma_f32 v78, v194, v4, v154
    v_fma_f32 v75, v175, v4, v135
    v_fma_f32 v79, v195, v4, v155
    v_fma_f32 v80, v76, v4, v72
    v_fma_f32 v84, v76, -v4, v72
    v_fma_f32 v81, v77, v4, v73
    v_fma_f32 v85, v77, -v4, v73
    v_fma_f32 v82, v78, v4, v74
    v_fma_f32 v86, v78, -v4, v74
    v_fma_f32 v83, v79, v4, v75
    v_fma_f32 v87, v79, -v4, v75
    v_cvt_pk_bf16_f32 v36, v80, v81
    v_cvt_pk_bf16_f32 v37, v82, v83
    v_cvt_pk_bf16_f32 v38, v84, v85
    v_cvt_pk_bf16_f32 v39, v86, v87
    s_nop 1
    v_permlane16_swap_b32 v36, v38
    v_permlane16_swap_b32 v37, v39
    s_nop 0
    buffer_store_dwordx4 v[36:39], v9, s[28:31], s36 offen nt
    v_add_u32 v14, 32, v13
    v_lshrrev_b32 v15, 5, v14
    v_and_b32 v14, 31, v14
    v_lshl_add_u32 v14, v14, 4, v3
    v_lshl_add_u32 v10, v15, 15, v14
    v_fma_f32 v90, v196, v4, v176
    v_fma_f32 v72, v176, v6, v136
    v_fma_f32 v76, v196, v6, v156
    v_fma_f32 v73, v177, v4, v137
    v_fma_f32 v77, v197, v4, v157
    v_fma_f32 v74, v178, v4, v138
    v_fma_f32 v78, v198, v4, v158
    v_fma_f32 v75, v179, v4, v139
    v_fma_f32 v79, v199, v4, v159
    v_fma_f32 v80, v76, v4, v72
    v_fma_f32 v84, v76, -v4, v72
    v_fma_f32 v81, v77, v4, v73
    v_fma_f32 v85, v77, -v4, v73
    v_fma_f32 v82, v78, v4, v74
    v_fma_f32 v86, v78, -v4, v74
    v_fma_f32 v83, v79, v4, v75
    v_fma_f32 v87, v79, -v4, v75
    v_cvt_pk_bf16_f32 v40, v80, v81
    v_cvt_pk_bf16_f32 v41, v82, v83
    v_cvt_pk_bf16_f32 v42, v84, v85
    v_cvt_pk_bf16_f32 v43, v86, v87
    s_nop 1
    v_permlane16_swap_b32 v40, v42
    v_permlane16_swap_b32 v41, v43
    s_nop 0
    buffer_store_dwordx4 v[40:43], v10, s[28:31], s36 offen nt
    v_add_u32 v14, 48, v13
    v_lshrrev_b32 v15, 5, v14
    v_and_b32 v14, 31, v14
    v_lshl_add_u32 v14, v14, 4, v3
    v_lshl_add_u32 v11, v15, 15, v14
    v_fma_f32 v91, v200, v4, v180
    v_fma_f32 v72, v180, v6, v140
    v_fma_f32 v76, v200, v6, v160
    v_fma_f32 v73, v181, v4, v141
    v_fma_f32 v77, v201, v4, v161
    v_fma_f32 v74, v182, v4, v142
    v_fma_f32 v78, v202, v4, v162
    v_fma_f32 v75, v183, v4, v143
    v_fma_f32 v79, v203, v4, v163
    v_fma_f32 v80, v76, v4, v72
    v_fma_f32 v84, v76, -v4, v72
    v_fma_f32 v81, v77, v4, v73
    v_fma_f32 v85, v77, -v4, v73
    v_fma_f32 v82, v78, v4, v74
    v_fma_f32 v86, v78, -v4, v74
    v_fma_f32 v83, v79, v4, v75
    v_fma_f32 v87, v79, -v4, v75
    v_cvt_pk_bf16_f32 v44, v80, v81
    v_cvt_pk_bf16_f32 v45, v82, v83
    v_cvt_pk_bf16_f32 v46, v84, v85
    v_cvt_pk_bf16_f32 v47, v86, v87
    s_nop 1
    v_permlane16_swap_b32 v44, v46
    v_permlane16_swap_b32 v45, v47
    s_nop 0
    buffer_store_dwordx4 v[44:47], v11, s[28:31], s36 offen nt
    v_add_u32 v14, 64, v13
    v_lshrrev_b32 v15, 5, v14
    v_and_b32 v14, 31, v14
    v_lshl_add_u32 v14, v14, 4, v3
    v_lshl_add_u32 v12, v15, 15, v14
    v_fma_f32 v92, v204, v4, v184
    v_fma_f32 v72, v184, v6, v144
    v_fma_f32 v76, v204, v6, v164
    v_fma_f32 v73, v185, v4, v145
    v_fma_f32 v77, v205, v4, v165
    v_fma_f32 v74, v186, v4, v146
    v_fma_f32 v78, v206, v4, v166
    v_fma_f32 v75, v187, v4, v147
    v_fma_f32 v79, v207, v4, v167
    v_fma_f32 v80, v76, v4, v72
    v_fma_f32 v84, v76, -v4, v72
    v_fma_f32 v81, v77, v4, v73
    v_fma_f32 v85, v77, -v4, v73
    v_fma_f32 v82, v78, v4, v74
    v_fma_f32 v86, v78, -v4, v74
    v_fma_f32 v83, v79, v4, v75
    v_fma_f32 v87, v79, -v4, v75
    v_cvt_pk_bf16_f32 v48, v80, v81
    v_cvt_pk_bf16_f32 v49, v82, v83
    v_cvt_pk_bf16_f32 v50, v84, v85
    v_cvt_pk_bf16_f32 v51, v86, v87
    s_nop 1
    v_permlane16_swap_b32 v48, v50
    v_permlane16_swap_b32 v49, v51
    s_nop 0
    buffer_store_dwordx4 v[48:51], v12, s[28:31], s36 offen nt
    s_cmp_eq_u32 s40, 0
    s_cbranch_scc1 K1_end
    v_lshl_add_u32 v14, v13, 2, s39
    v_mov_b32 v15, 1280
    v_cndmask_b32 v15, v14, v15, s[48:49]
    s_mov_b32 s36, 9441280
    s_mov_b64 exec, 0xffff
    buffer_store_dword v88, v15, s[28:31], s36 offen
    buffer_store_dword v89, v14, s[28:31], s36 offen offset:64
    buffer_store_dword v90, v14, s[28:31], s36 offen offset:128
    buffer_store_dword v91, v14, s[28:31], s36 offen offset:192
    buffer_store_dword v92, v14, s[28:31], s36 offen offset:256
K1_end:
    s_endpgm
.globl k2_kernel
.p2align 8
.type k2_kernel,@function
k2_kernel:
    s_cmp_ge_u32 s2, 256
    s_cbranch_scc1 K2_end
    s_getpc_b64 s[84:85]
K2_pc:
    v_lshlrev_b32 v2, 7, v0
    v_min_u32 v2, TEXT_END-K2_pc-4, v2
    global_load_dword v131, v2, s[84:85]
    s_load_dwordx2 s[12:13], s[0:1], 88
    v_lshrrev_b32 v1, 6, v0
    v_and_b32 v0, 63, v0
    s_and_b32 s18, s2, 7
    s_lshr_b32 s19, s2, 3
    v_readfirstlane_b32 s16, v1
    s_and_b32 s14, s19, 7
    s_lshr_b32 s3, s18, 1
    s_lshl_b32 s3, s3, 3
    s_add_u32 s14, s14, s3
    s_and_b32 s49, s18, 1
    s_lshl_b32 s49, s49, 2
    s_lshr_b32 s15, s19, 3
    s_add_u32 s15, s15, s49
    s_mul_i32 s17, s14, 167936
    s_add_u32 s17, s17, 2621440
    v_lshlrev_b32 v128, 4, v0
    s_mov_b32 s30, 268435456
    s_mov_b32 s31, 0x20000
    s_cmp_ge_u32 s16, 8
    s_waitcnt lgkmcnt(0)
    s_mov_b32 s28, s12
    s_mov_b32 s29, s13
    s_cbranch_scc1 K2_bg
    s_setprio 3
    s_lshr_b32 s3, s16, 2
    s_lshl_b32 s20, s15, 1
    s_add_u32 s20, s20, s3
    s_mul_i32 s20, s20, 5120
    s_mul_i32 s3, s14, 81920
    s_add_u32 s20, s20, s3
    s_and_b32 s21, s16, 3
    s_lshl_b32 s3, s21, 10
    s_add_u32 s22, s20, s3
    s_lshr_b32 s3, s21, 1
    s_lshl_b32 s3, s3, 9
    s_add_u32 s23, s20, s3
    s_and_b32 s3, s21, 1
    s_lshl_b32 s3, s3, 3
    s_add_u32 s23, s23, s3
    s_add_u32 s23, s23, 4096
    v_and_b32 v1, 31, v0
    v_lshlrev_b32 v2, 4, v1
    buffer_load_dwordx4 v[4:7], v128, s[28:31], s22 offen
    buffer_load_dwordx2 v[10:11], v2, s[28:31], s23 offen
    v_lshrrev_b32 v3, 5, v0
    v_mul_u32_u24 v3, 336, v3
    v_add3_u32 v129, v2, v3, 0
    v_add_u32 v129, 5120, v129
    v_mov_b32 v124, v128
    v_mov_b32 v126, v129
    v_add_u32 v125, 20992, v128
    v_add_u32 v127, 20992, v129
    s_mov_b32 s42, -1
    s_mov_b32 s43, 0
    s_mov_b32 s45, 20992
    s_mov_b32 s46, 0
    s_mov_b32 s47, 0
    s_mov_b32 s52, 2
    v_and_b32 v8, 3, v0
    v_lshlrev_b32 v8, 2, v8
    v_add_u32 v8, 83968, v8
    s_lshl_b32 s3, s16, 8
    s_add_u32 s3, s3, 84224
    v_lshl_add_u32 v12, v0, 2, s3
    v_mov_b32 v13, 0
    ds_write_b32 v12, v13
    s_mov_b32 s40, 0x1fffff
    s_mov_b32 s41, 0x1fffff
    v_mov_b32 v108, 0
    v_mov_b32 v109, 0
    v_mov_b32 v110, 0
    v_mov_b32 v111, 0
    v_mov_b32 v112, 0
    v_mov_b32 v113, 0
    v_mov_b32 v114, 0
    v_mov_b32 v115, 0
    v_mov_b32 v116, 0
    v_mov_b32 v117, 0
    v_mov_b32 v118, 0
    v_mov_b32 v119, 0
    v_mov_b32 v120, 0
    v_mov_b32 v121, 0
    v_mov_b32 v122, 0
    v_mov_b32 v123, 0
    v_mov_b32 v76, 0
    v_mov_b32 v77, 0
    v_mov_b32 v78, 0
    v_mov_b32 v79, 0
    v_mov_b32 v80, 0
    v_mov_b32 v81, 0
    v_mov_b32 v82, 0
    v_mov_b32 v83, 0
    v_mov_b32 v84, 0
    v_mov_b32 v85, 0
    v_mov_b32 v86, 0
    v_mov_b32 v87, 0
    v_mov_b32 v88, 0
    v_mov_b32 v89, 0
    v_mov_b32 v90, 0
    v_mov_b32 v91, 0
    v_mov_b32 v72, 0
    v_mov_b32 v73, 0
    v_mov_b32 v74, 0
    v_mov_b32 v75, 0
    s_waitcnt lgkmcnt(0)
    s_barrier
    ds_read_b128 v[92:95], v124
    ds_read_b128 v[100:103], v124 offset:4096
    ds_read_b128 v[96:99], v124 offset:1024
    s_mov_b64 exec, s[40:41]
    ds_read_b128 v[108:111], v126
    ds_read_b128 v[112:115], v126 offset:672
    s_mov_b64 exec, -1
    s_waitcnt vmcnt(0)
    v_cndmask_b32 v16, v10, 0, s[42:43]
    v_cndmask_b32 v17, v11, 0, s[42:43]
    v_cndmask_b32 v10, 0, v10, s[42:43]
    v_cndmask_b32 v11, 0, v11, s[42:43]
    s_waitcnt lgkmcnt(0)
    v_mfma_f32_32x32x16_bf16 v[36:51], v[92:95], v[4:7], 0
    s_nop 9
    v_mfma_f32_32x32x8_bf16 v[36:51], v[100:101], v[10:11], v[36:51]
    s_nop 15
    v_max3_f32 v1, v36, v37, v38
    v_max3_f32 v2, v39, v40, v41
    v_max3_f32 v1, v1, v42, v43
    v_max3_f32 v2, v2, v44, v45
    v_max3_f32 v1, v1, v46, v47
    v_max3_f32 v2, v2, v48, v49
    v_max3_f32 v1, v1, v50, v51
    v_max_f32 v1, v1, v2
    v_mov_b32 v2, v1
    s_nop 1
    v_permlane32_swap_b32 v1, v2
    v_max_f32 v1, v1, v2
    v_sub_f32 v20, 0, v1
    v_mov_b32 v21, v20
    v_mov_b32 v22, v20
    v_mov_b32 v23, v20
    v_mov_b32 v24, v20
    v_mov_b32 v25, v20
    v_mov_b32 v26, v20
    v_mov_b32 v27, v20
    v_mov_b32 v28, v20
    v_mov_b32 v29, v20
    v_mov_b32 v30, v20
    v_mov_b32 v31, v20
    v_mov_b32 v32, v20
    v_mov_b32 v33, v20
    v_mov_b32 v34, v20
    v_mov_b32 v35, v20
    v_add_f32 v36, v36, v20
    v_add_f32 v37, v37, v20
    v_add_f32 v38, v38, v20
    v_add_f32 v39, v39, v20
    v_add_f32 v40, v40, v20
    v_add_f32 v41, v41, v20
    v_add_f32 v42, v42, v20
    v_add_f32 v43, v43, v20
    v_add_f32 v44, v44, v20
    v_add_f32 v45, v45, v20
    v_add_f32 v46, v46, v20
    v_add_f32 v47, v47, v20
    v_add_f32 v48, v48, v20
    v_add_f32 v49, v49, v20
    v_add_f32 v50, v50, v20
    v_add_f32 v51, v51, v20
K2_loop:
    s_waitcnt lgkmcnt(0)
    s_setprio 3
    v_mfma_f32_32x32x16_bf16 v[52:67], v[96:99], v[4:7], v[20:35]
    v_exp_f32 v36, v36
    v_exp_f32 v37, v37
    ds_read_b128 v[92:95], v124 offset:2048
    v_exp_f32 v38, v38
    v_exp_f32 v39, v39
    v_mfma_f32_32x32x8_bf16 v[52:67], v[102:103], v[10:11], v[52:67]
    v_exp_f32 v40, v40
    v_exp_f32 v41, v41
    v_exp_f32 v42, v42
    v_exp_f32 v43, v43
    v_cvt_pk_bf16_f32 v68, v36, v37
    v_cvt_pk_bf16_f32 v69, v38, v39
    v_cvt_pk_bf16_f32 v70, v40, v41
    v_cvt_pk_bf16_f32 v71, v42, v43
    v_mfma_f32_32x32x16_bf16 v[76:91], v[120:123], v[72:75], v[76:91]
    v_exp_f32 v44, v44
    v_exp_f32 v45, v45
    s_mov_b64 exec, s[40:41]
    ds_read_b128 v[116:119], v126 offset:1344
    ds_read_b128 v[120:123], v126 offset:2016
    s_mov_b64 exec, -1
    v_exp_f32 v46, v46
    v_exp_f32 v47, v47
    v_mfma_f32_32x32x16_bf16 v[76:91], v[108:111], v[68:71], v[76:91]
    v_exp_f32 v48, v48
    v_exp_f32 v49, v49
    v_exp_f32 v50, v50
    v_exp_f32 v51, v51
    v_cvt_pk_bf16_f32 v72, v44, v45
    v_cvt_pk_bf16_f32 v73, v46, v47
    v_cvt_pk_bf16_f32 v74, v48, v49
    v_cvt_pk_bf16_f32 v75, v50, v51
    s_waitcnt lgkmcnt(0)
    v_mfma_f32_32x32x16_bf16 v[36:51], v[92:95], v[4:7], v[20:35]
    v_exp_f32 v52, v52
    v_exp_f32 v53, v53
    ds_read_b128 v[96:99], v124 offset:3072
    v_exp_f32 v54, v54
    v_exp_f32 v55, v55
    v_mfma_f32_32x32x8_bf16 v[36:51], v[100:101], v[16:17], v[36:51]
    v_exp_f32 v56, v56
    v_exp_f32 v57, v57
    v_exp_f32 v58, v58
    v_exp_f32 v59, v59
    v_cvt_pk_bf16_f32 v68, v52, v53
    v_cvt_pk_bf16_f32 v69, v54, v55
    v_cvt_pk_bf16_f32 v70, v56, v57
    v_cvt_pk_bf16_f32 v71, v58, v59
    v_mfma_f32_32x32x16_bf16 v[76:91], v[112:115], v[72:75], v[76:91]
    v_exp_f32 v60, v60
    v_exp_f32 v61, v61
    s_mov_b64 exec, s[40:41]
    ds_read_b128 v[108:111], v126 offset:2688
    ds_read_b128 v[112:115], v126 offset:3360
    s_mov_b64 exec, -1
    v_exp_f32 v62, v62
    v_exp_f32 v63, v63
    v_mfma_f32_32x32x16_bf16 v[76:91], v[116:119], v[68:71], v[76:91]
    v_exp_f32 v64, v64
    v_exp_f32 v65, v65
    v_exp_f32 v66, v66
    v_exp_f32 v67, v67
    v_cvt_pk_bf16_f32 v72, v60, v61
    v_cvt_pk_bf16_f32 v73, v62, v63
    v_cvt_pk_bf16_f32 v74, v64, v65
    v_cvt_pk_bf16_f32 v75, v66, v67
    s_waitcnt lgkmcnt(0)
    s_setprio 2
    v_mfma_f32_32x32x16_bf16 v[52:67], v[96:99], v[4:7], v[20:35]
    v_exp_f32 v36, v36
    v_exp_f32 v37, v37
    ds_read_b128 v[92:95], v124 offset:10496
    v_exp_f32 v38, v38
    v_exp_f32 v39, v39
    v_mfma_f32_32x32x8_bf16 v[52:67], v[102:103], v[16:17], v[52:67]
    v_exp_f32 v40, v40
    v_exp_f32 v41, v41
    ds_read_b128 v[104:107], v124 offset:14592
    v_exp_f32 v42, v42
    v_exp_f32 v43, v43
    v_cvt_pk_bf16_f32 v68, v36, v37
    v_cvt_pk_bf16_f32 v69, v38, v39
    v_cvt_pk_bf16_f32 v70, v40, v41
    v_cvt_pk_bf16_f32 v71, v42, v43
    v_mfma_f32_32x32x16_bf16 v[76:91], v[120:123], v[72:75], v[76:91]
    v_exp_f32 v44, v44
    v_exp_f32 v45, v45
    s_mov_b64 exec, s[40:41]
    ds_read_b128 v[116:119], v126 offset:4032
    ds_read_b128 v[120:123], v126 offset:4704
    s_mov_b64 exec, -1
    v_exp_f32 v46, v46
    v_exp_f32 v47, v47
    v_mfma_f32_32x32x16_bf16 v[76:91], v[108:111], v[68:71], v[76:91]
    v_exp_f32 v48, v48
    v_exp_f32 v49, v49
    v_exp_f32 v50, v50
    v_exp_f32 v51, v51
    v_cvt_pk_bf16_f32 v72, v44, v45
    v_cvt_pk_bf16_f32 v73, v46, v47
    v_cvt_pk_bf16_f32 v74, v48, v49
    v_cvt_pk_bf16_f32 v75, v50, v51
    s_waitcnt lgkmcnt(0)
    v_mfma_f32_32x32x16_bf16 v[36:51], v[92:95], v[4:7], v[20:35]
    v_exp_f32 v52, v52
    v_exp_f32 v53, v53
    ds_read_b128 v[96:99], v124 offset:11520
    v_exp_f32 v54, v54
    v_exp_f32 v55, v55
    v_mfma_f32_32x32x8_bf16 v[36:51], v[104:105], v[10:11], v[36:51]
    v_exp_f32 v56, v56
    v_exp_f32 v57, v57
    v_exp_f32 v58, v58
    v_exp_f32 v59, v59
    v_cvt_pk_bf16_f32 v68, v52, v53
    v_cvt_pk_bf16_f32 v69, v54, v55
    v_cvt_pk_bf16_f32 v70, v56, v57
    v_cvt_pk_bf16_f32 v71, v58, v59
    v_mfma_f32_32x32x16_bf16 v[76:91], v[112:115], v[72:75], v[76:91]
    v_exp_f32 v60, v60
    v_exp_f32 v61, v61
    s_mov_b64 exec, s[40:41]
    ds_read_b128 v[108:111], v126 offset:10496
    ds_read_b128 v[112:115], v126 offset:11168
    s_mov_b64 exec, -1
    v_exp_f32 v62, v62
    v_exp_f32 v63, v63
    v_mfma_f32_32x32x16_bf16 v[76:91], v[116:119], v[68:71], v[76:91]
    v_exp_f32 v64, v64
    v_exp_f32 v65, v65
    v_exp_f32 v66, v66
    v_exp_f32 v67, v67
    v_cvt_pk_bf16_f32 v72, v60, v61
    v_cvt_pk_bf16_f32 v73, v62, v63
    v_cvt_pk_bf16_f32 v74, v64, v65
    v_cvt_pk_bf16_f32 v75, v66, v67
    s_waitcnt lgkmcnt(0)
    s_setprio 1
    v_mfma_f32_32x32x16_bf16 v[52:67], v[96:99], v[4:7], v[20:35]
    v_exp_f32 v36, v36
    v_exp_f32 v37, v37
    ds_read_b128 v[92:95], v124 offset:12544
    v_exp_f32 v38, v38
    v_exp_f32 v39, v39
    v_mfma_f32_32x32x8_bf16 v[52:67], v[106:107], v[10:11], v[52:67]
    v_exp_f32 v40, v40
    v_exp_f32 v41, v41
    v_exp_f32 v42, v42
    v_exp_f32 v43, v43
    v_cvt_pk_bf16_f32 v68, v36, v37
    v_cvt_pk_bf16_f32 v69, v38, v39
    v_cvt_pk_bf16_f32 v70, v40, v41
    v_cvt_pk_bf16_f32 v71, v42, v43
    v_mfma_f32_32x32x16_bf16 v[76:91], v[120:123], v[72:75], v[76:91]
    v_exp_f32 v44, v44
    v_exp_f32 v45, v45
    s_mov_b64 exec, s[40:41]
    ds_read_b128 v[116:119], v126 offset:11840
    ds_read_b128 v[120:123], v126 offset:12512
    s_mov_b64 exec, -1
    v_exp_f32 v46, v46
    v_exp_f32 v47, v47
    v_mfma_f32_32x32x16_bf16 v[76:91], v[108:111], v[68:71], v[76:91]
    v_exp_f32 v48, v48
    v_exp_f32 v49, v49
    v_exp_f32 v50, v50
    v_exp_f32 v51, v51
    v_cvt_pk_bf16_f32 v72, v44, v45
    v_cvt_pk_bf16_f32 v73, v46, v47
    v_cvt_pk_bf16_f32 v74, v48, v49
    v_cvt_pk_bf16_f32 v75, v50, v51
    s_waitcnt lgkmcnt(0)
    v_mfma_f32_32x32x16_bf16 v[36:51], v[92:95], v[4:7], v[20:35]
    v_exp_f32 v52, v52
    v_exp_f32 v53, v53
    ds_read_b128 v[96:99], v124 offset:13568
    v_exp_f32 v54, v54
    v_exp_f32 v55, v55
    v_mfma_f32_32x32x8_bf16 v[36:51], v[104:105], v[16:17], v[36:51]
    v_exp_f32 v56, v56
    v_exp_f32 v57, v57
    ds_read_b32 v9, v8
    v_exp_f32 v58, v58
    v_exp_f32 v59, v59
    v_cvt_pk_bf16_f32 v68, v52, v53
    v_cvt_pk_bf16_f32 v69, v54, v55
    v_cvt_pk_bf16_f32 v70, v56, v57
    v_cvt_pk_bf16_f32 v71, v58, v59
    v_mfma_f32_32x32x16_bf16 v[76:91], v[112:115], v[72:75], v[76:91]
    v_exp_f32 v60, v60
    v_exp_f32 v61, v61
    s_mov_b64 exec, s[40:41]
    ds_read_b128 v[108:111], v126 offset:13184
    ds_read_b128 v[112:115], v126 offset:13856
    s_mov_b64 exec, -1
    v_exp_f32 v62, v62
    v_exp_f32 v63, v63
    v_mfma_f32_32x32x16_bf16 v[76:91], v[116:119], v[68:71], v[76:91]
    v_exp_f32 v64, v64
    v_exp_f32 v65, v65
    v_exp_f32 v66, v66
    v_exp_f32 v67, v67
    v_cvt_pk_bf16_f32 v72, v60, v61
    v_cvt_pk_bf16_f32 v73, v62, v63
    v_cvt_pk_bf16_f32 v74, v64, v65
    v_cvt_pk_bf16_f32 v75, v66, v67
    s_waitcnt lgkmcnt(0)
    s_setprio 0
    v_cmp_le_u32 vcc, s52, v9
    v_mfma_f32_32x32x16_bf16 v[52:67], v[96:99], v[4:7], v[20:35]
    v_exp_f32 v36, v36
    v_exp_f32 v37, v37
    s_cmp_eq_u64 vcc, -1
    s_cbranch_scc0 K2_slow
K2_back:
    ds_read_b128 v[92:95], v125 offset:0
    v_exp_f32 v38, v38
    v_exp_f32 v39, v39
    v_mfma_f32_32x32x8_bf16 v[52:67], v[106:107], v[16:17], v[52:67]
    v_exp_f32 v40, v40
    v_exp_f32 v41, v41
    ds_read_b128 v[100:103], v125 offset:4096
    v_exp_f32 v42, v42
    v_exp_f32 v43, v43
    v_cvt_pk_bf16_f32 v68, v36, v37
    v_cvt_pk_bf16_f32 v69, v38, v39
    v_cvt_pk_bf16_f32 v70, v40, v41
    v_cvt_pk_bf16_f32 v71, v42, v43
    v_mfma_f32_32x32x16_bf16 v[76:91], v[120:123], v[72:75], v[76:91]
    v_exp_f32 v44, v44
    v_exp_f32 v45, v45
    s_mov_b64 exec, s[40:41]
    ds_read_b128 v[116:119], v126 offset:14528
    ds_read_b128 v[120:123], v126 offset:15200
    s_mov_b64 exec, -1
    v_exp_f32 v46, v46
    v_exp_f32 v47, v47
    v_mfma_f32_32x32x16_bf16 v[76:91], v[108:111], v[68:71], v[76:91]
    v_exp_f32 v48, v48
    v_exp_f32 v49, v49
    v_exp_f32 v50, v50
    v_exp_f32 v51, v51
    v_cvt_pk_bf16_f32 v72, v44, v45
    v_cvt_pk_bf16_f32 v73, v46, v47
    v_cvt_pk_bf16_f32 v74, v48, v49
    v_cvt_pk_bf16_f32 v75, v50, v51
    s_waitcnt lgkmcnt(0)
    v_add_u32 v13, 1, v13
    v_mfma_f32_32x32x16_bf16 v[36:51], v[92:95], v[4:7], v[20:35]
    v_exp_f32 v52, v52
    v_exp_f32 v53, v53
    ds_read_b128 v[96:99], v125 offset:1024
    v_exp_f32 v54, v54
    v_exp_f32 v55, v55
    v_mfma_f32_32x32x8_bf16 v[36:51], v[100:101], v[10:11], v[36:51]
    v_exp_f32 v56, v56
    v_exp_f32 v57, v57
    ds_write_b32 v12, v13
    v_exp_f32 v58, v58
    v_exp_f32 v59, v59
    v_cvt_pk_bf16_f32 v68, v52, v53
    v_cvt_pk_bf16_f32 v69, v54, v55
    v_cvt_pk_bf16_f32 v70, v56, v57
    v_cvt_pk_bf16_f32 v71, v58, v59
    v_mfma_f32_32x32x16_bf16 v[76:91], v[112:115], v[72:75], v[76:91]
    v_exp_f32 v60, v60
    v_exp_f32 v61, v61
    s_mov_b64 exec, s[40:41]
    ds_read_b128 v[108:111], v127 offset:0
    ds_read_b128 v[112:115], v127 offset:672
    s_mov_b64 exec, -1
    v_exp_f32 v62, v62
    v_exp_f32 v63, v63
    v_mfma_f32_32x32x16_bf16 v[76:91], v[116:119], v[68:71], v[76:91]
    v_exp_f32 v64, v64
    v_exp_f32 v65, v65
    v_exp_f32 v66, v66
    v_exp_f32 v67, v67
    v_cvt_pk_bf16_f32 v72, v60, v61
    v_cvt_pk_bf16_f32 v73, v62, v63
    v_cvt_pk_bf16_f32 v74, v64, v65
    v_cvt_pk_bf16_f32 v75, v66, v67
    s_add_u32 s45, s45, 20992
    s_cmp_eq_u32 s45, 83968
    s_cselect_b32 s45, 0, s45
    v_mov_b32 v124, v125
    v_mov_b32 v126, v127
    v_add_u32 v125, s45, v128
    v_add_u32 v127, s45, v129
    s_add_u32 s52, s52, 1
    s_min_u32 s52, s52, 8
    s_add_u32 s46, s46, 1
    s_cmp_lt_u32 s46, 8
    s_cbranch_scc1 K2_loop
    v_mfma_f32_32x32x16_bf16 v[76:91], v[120:123], v[72:75], v[76:91]
K2_fin:
    s_lshl_b32 s3, s15, 4
    s_lshl_b32 s20, s16, 1
    s_add_u32 s20, s20, s3
    s_mul_i32 s20, s20, 20480
    s_add_u32 s20, s20, 12517376
    s_lshr_b32 s3, s14, 1
    s_lshl_b32 s21, s3, 10
    s_and_b32 s22, s14, 1
    s_lshl_b32 s23, s22, 9
    s_add_u32 s21, s21, s23
    s_add_u32 s21, s21, s20
    s_lshl_b32 s3, s3, 8
    s_lshl_b32 s22, s22, 3
    s_add_u32 s22, s22, s3
    s_add_u32 s22, s22, s20
    s_add_u32 s22, s22, 16384
    v_and_b32 v1, 15, v0
    v_bfe_u32 v2, v0, 4, 1
    v_mul_u32_u24 v2, 20480, v2
    v_lshl_add_u32 v1, v1, 4, v2
    v_lshrrev_b32 v2, 5, v0
    v_lshl_add_u32 v2, v2, 8, v1
    s_nop 3
    v_mov_b32 v92, v84
    v_mov_b32 v93, v84
    v_max3_f32 v3, |v76|, |v77|, |v78|
    v_max3_f32 v3, v3, |v79|, |v80|
    v_permlane32_swap_b32 v92, v93
    v_max3_f32 v3, v3, |v81|, |v82|
    v_max3_f32 v3, v3, |v83|, |v84|
    v_cndmask_b32 v96, 0, v85, s[42:43]
    v_cndmask_b32 v97, 0, v86, s[42:43]
    v_cndmask_b32 v98, 0, v87, s[42:43]
    v_rcp_f32 v94, v93
    v_add_f32 v99, v76, v77
    v_max3_f32 v3, v3, |v96|, |v97|
    v_max_f32 v3, v3, |v98|
    s_mov_b32 s3, 1904214016
    v_cmp_ngt_f32 vcc, s3, v3
    v_cmp_u_f32 s[24:25], v76, v77
    s_or_b64 vcc, vcc, s[24:25]
    v_cmp_u_f32 s[24:25], v78, v79
    s_or_b64 vcc, vcc, s[24:25]
    v_cmp_u_f32 s[24:25], v80, v81
    s_or_b64 vcc, vcc, s[24:25]
    v_cmp_u_f32 s[24:25], v82, v83
    s_or_b64 vcc, vcc, s[24:25]
    v_cmp_u_f32 s[24:25], v84, v96
    s_or_b64 vcc, vcc, s[24:25]
    v_cmp_u_f32 s[24:25], v97, v98
    s_or_b64 vcc, vcc, s[24:25]
    s_cmp_eq_u64 vcc, 0
    s_cbranch_scc1 K2_store
    s_cmp_eq_u32 s47, 0
    s_cbranch_scc1 K2_fallback
K2_store:
    v_mul_f32 v76, v76, v94
    v_mul_f32 v77, v77, v94
    v_mul_f32 v78, v78, v94
    v_mul_f32 v79, v79, v94
    v_mul_f32 v80, v80, v94
    v_mul_f32 v81, v81, v94
    v_mul_f32 v82, v82, v94
    v_mul_f32 v83, v83, v94
    v_mul_f32 v84, v84, v94
    v_mul_f32 v85, v85, v94
    v_mul_f32 v86, v86, v94
    v_mul_f32 v87, v87, v94
    v_cvt_pk_bf16_f32 v68, v76, v77
    v_cvt_pk_bf16_f32 v69, v78, v79
    v_cvt_pk_bf16_f32 v70, v80, v81
    v_cvt_pk_bf16_f32 v71, v82, v83
    v_cvt_pk_bf16_f32 v72, v84, v85
    v_cvt_pk_bf16_f32 v73, v86, v87
    buffer_store_dwordx4 v[68:71], v2, s[28:31], s21 offen
    s_mov_b64 exec, s[42:43]
    buffer_store_dwordx2 v[72:73], v1, s[28:31], s22 offen
    s_endpgm
K2_slow:
    s_sleep 1
    ds_read_b32 v9, v8
    s_waitcnt lgkmcnt(0)
    v_cmp_le_u32 vcc, s52, v9
    s_nop 1
    s_cmp_eq_u64 vcc, -1
    s_cbranch_scc0 K2_slow
    s_branch K2_back
K2_fallback:
    s_mov_b32 s47, 1
    v_mov_b32 v3, 0xff800000
    s_mov_b32 s46, 0
    s_mov_b32 s20, s17
K2_fbA:
    s_add_u32 s21, s20, 4096
    buffer_load_dwordx4 v[100:103], v128, s[28:31], s21 offen
    buffer_load_dwordx4 v[92:95], v128, s[28:31], s20 offen offset:0
    s_waitcnt vmcnt(0)
    v_mfma_f32_32x32x16_bf16 v[36:51], v[92:95], v[4:7], 0
    s_nop 9
    v_mfma_f32_32x32x8_bf16 v[36:51], v[100:101], v[10:11], v[36:51]
    s_nop 15
    v_max3_f32 v3, v3, v36, v37
    v_max3_f32 v3, v3, v38, v39
    v_max3_f32 v3, v3, v40, v41
    v_max3_f32 v3, v3, v42, v43
    v_max3_f32 v3, v3, v44, v45
    v_max3_f32 v3, v3, v46, v47
    v_max3_f32 v3, v3, v48, v49
    v_max3_f32 v3, v3, v50, v51
    buffer_load_dwordx4 v[92:95], v128, s[28:31], s20 offen offset:1024
    s_waitcnt vmcnt(0)
    v_mfma_f32_32x32x16_bf16 v[36:51], v[92:95], v[4:7], 0
    s_nop 9
    v_mfma_f32_32x32x8_bf16 v[36:51], v[102:103], v[10:11], v[36:51]
    s_nop 15
    v_max3_f32 v3, v3, v36, v37
    v_max3_f32 v3, v3, v38, v39
    v_max3_f32 v3, v3, v40, v41
    v_max3_f32 v3, v3, v42, v43
    v_max3_f32 v3, v3, v44, v45
    v_max3_f32 v3, v3, v46, v47
    v_max3_f32 v3, v3, v48, v49
    v_max3_f32 v3, v3, v50, v51
    buffer_load_dwordx4 v[92:95], v128, s[28:31], s20 offen offset:2048
    s_waitcnt vmcnt(0)
    v_mfma_f32_32x32x16_bf16 v[36:51], v[92:95], v[4:7], 0
    s_nop 9
    v_mfma_f32_32x32x8_bf16 v[36:51], v[100:101], v[16:17], v[36:51]
    s_nop 15
    v_max3_f32 v3, v3, v36, v37
    v_max3_f32 v3, v3, v38, v39
    v_max3_f32 v3, v3, v40, v41
    v_max3_f32 v3, v3, v42, v43
    v_max3_f32 v3, v3, v44, v45
    v_max3_f32 v3, v3, v46, v47
    v_max3_f32 v3, v3, v48, v49
    v_max3_f32 v3, v3, v50, v51
    buffer_load_dwordx4 v[92:95], v128, s[28:31], s20 offen offset:3072
    s_waitcnt vmcnt(0)
    v_mfma_f32_32x32x16_bf16 v[36:51], v[92:95], v[4:7], 0
    s_nop 9
    v_mfma_f32_32x32x8_bf16 v[36:51], v[102:103], v[16:17], v[36:51]
    s_nop 15
    v_max3_f32 v3, v3, v36, v37
    v_max3_f32 v3, v3, v38, v39
    v_max3_f32 v3, v3, v40, v41
    v_max3_f32 v3, v3, v42, v43
    v_max3_f32 v3, v3, v44, v45
    v_max3_f32 v3, v3, v46, v47
    v_max3_f32 v3, v3, v48, v49
    v_max3_f32 v3, v3, v50, v51
    s_add_u32 s20, s20, 10496
    s_add_u32 s46, s46, 1
    s_cmp_lt_u32 s46, 16
    s_cbranch_scc1 K2_fbA
    v_mov_b32 v2, v3
    s_nop 1
    v_permlane32_swap_b32 v3, v2
    v_max_f32 v3, v3, v2
    v_sub_f32 v20, 0, v3
    v_mov_b32 v21, v20
    v_mov_b32 v22, v20
    v_mov_b32 v23, v20
    v_mov_b32 v24, v20
    v_mov_b32 v25, v20
    v_mov_b32 v26, v20
    v_mov_b32 v27, v20
    v_mov_b32 v28, v20
    v_mov_b32 v29, v20
    v_mov_b32 v30, v20
    v_mov_b32 v31, v20
    v_mov_b32 v32, v20
    v_mov_b32 v33, v20
    v_mov_b32 v34, v20
    v_mov_b32 v35, v20
    v_mov_b32 v76, 0
    v_mov_b32 v77, 0
    v_mov_b32 v78, 0
    v_mov_b32 v79, 0
    v_mov_b32 v80, 0
    v_mov_b32 v81, 0
    v_mov_b32 v82, 0
    v_mov_b32 v83, 0
    v_mov_b32 v84, 0
    v_mov_b32 v85, 0
    v_mov_b32 v86, 0
    v_mov_b32 v87, 0
    v_mov_b32 v88, 0
    v_mov_b32 v89, 0
    v_mov_b32 v90, 0
    v_mov_b32 v91, 0
    s_mov_b32 s46, 0
    s_mov_b32 s20, s17
K2_fbB:
    s_add_u32 s21, s20, 4096
    buffer_load_dwordx4 v[100:103], v128, s[28:31], s21 offen
    buffer_load_dwordx4 v[92:95], v128, s[28:31], s20 offen offset:0
    s_add_u32 s21, s20, 0
    buffer_load_dwordx4 v[108:111], v129, s[28:31], s21 offen
    buffer_load_dwordx4 v[112:115], v129, s[28:31], s21 offen offset:672
    s_waitcnt vmcnt(0)
    v_mfma_f32_32x32x16_bf16 v[36:51], v[92:95], v[4:7], v[20:35]
    s_nop 9
    v_mfma_f32_32x32x8_bf16 v[36:51], v[100:101], v[10:11], v[36:51]
    s_nop 15
    v_exp_f32 v36, v36
    v_exp_f32 v37, v37
    v_exp_f32 v38, v38
    v_exp_f32 v39, v39
    v_exp_f32 v40, v40
    v_exp_f32 v41, v41
    v_exp_f32 v42, v42
    v_exp_f32 v43, v43
    v_exp_f32 v44, v44
    v_exp_f32 v45, v45
    v_exp_f32 v46, v46
    v_exp_f32 v47, v47
    v_exp_f32 v48, v48
    v_exp_f32 v49, v49
    v_exp_f32 v50, v50
    v_exp_f32 v51, v51
    s_nop 0
    v_cvt_pk_bf16_f32 v68, v36, v37
    v_cvt_pk_bf16_f32 v69, v38, v39
    v_cvt_pk_bf16_f32 v70, v40, v41
    v_cvt_pk_bf16_f32 v71, v42, v43
    v_cvt_pk_bf16_f32 v72, v44, v45
    v_cvt_pk_bf16_f32 v73, v46, v47
    v_cvt_pk_bf16_f32 v74, v48, v49
    v_cvt_pk_bf16_f32 v75, v50, v51
    s_nop 1
    v_mfma_f32_32x32x16_bf16 v[76:91], v[108:111], v[68:71], v[76:91]
    v_mfma_f32_32x32x16_bf16 v[76:91], v[112:115], v[72:75], v[76:91]
    s_nop 7
    buffer_load_dwordx4 v[92:95], v128, s[28:31], s20 offen offset:1024
    s_add_u32 s21, s20, 1344
    buffer_load_dwordx4 v[108:111], v129, s[28:31], s21 offen
    buffer_load_dwordx4 v[112:115], v129, s[28:31], s21 offen offset:672
    s_waitcnt vmcnt(0)
    v_mfma_f32_32x32x16_bf16 v[36:51], v[92:95], v[4:7], v[20:35]
    s_nop 9
    v_mfma_f32_32x32x8_bf16 v[36:51], v[102:103], v[10:11], v[36:51]
    s_nop 15
    v_exp_f32 v36, v36
    v_exp_f32 v37, v37
    v_exp_f32 v38, v38
    v_exp_f32 v39, v39
    v_exp_f32 v40, v40
    v_exp_f32 v41, v41
    v_exp_f32 v42, v42
    v_exp_f32 v43, v43
    v_exp_f32 v44, v44
    v_exp_f32 v45, v45
    v_exp_f32 v46, v46
    v_exp_f32 v47, v47
    v_exp_f32 v48, v48
    v_exp_f32 v49, v49
    v_exp_f32 v50, v50
    v_exp_f32 v51, v51
    s_nop 0
    v_cvt_pk_bf16_f32 v68, v36, v37
    v_cvt_pk_bf16_f32 v69, v38, v39
    v_cvt_pk_bf16_f32 v70, v40, v41
    v_cvt_pk_bf16_f32 v71, v42, v43
    v_cvt_pk_bf16_f32 v72, v44, v45
    v_cvt_pk_bf16_f32 v73, v46, v47
    v_cvt_pk_bf16_f32 v74, v48, v49
    v_cvt_pk_bf16_f32 v75, v50, v51
    s_nop 1
    v_mfma_f32_32x32x16_bf16 v[76:91], v[108:111], v[68:71], v[76:91]
    v_mfma_f32_32x32x16_bf16 v[76:91], v[112:115], v[72:75], v[76:91]
    s_nop 7
    buffer_load_dwordx4 v[92:95], v128, s[28:31], s20 offen offset:2048
    s_add_u32 s21, s20, 2688
    buffer_load_dwordx4 v[108:111], v129, s[28:31], s21 offen
    buffer_load_dwordx4 v[112:115], v129, s[28:31], s21 offen offset:672
    s_waitcnt vmcnt(0)
    v_mfma_f32_32x32x16_bf16 v[36:51], v[92:95], v[4:7], v[20:35]
    s_nop 9
    v_mfma_f32_32x32x8_bf16 v[36:51], v[100:101], v[16:17], v[36:51]
    s_nop 15
    v_exp_f32 v36, v36
    v_exp_f32 v37, v37
    v_exp_f32 v38, v38
    v_exp_f32 v39, v39
    v_exp_f32 v40, v40
    v_exp_f32 v41, v41
    v_exp_f32 v42, v42
    v_exp_f32 v43, v43
    v_exp_f32 v44, v44
    v_exp_f32 v45, v45
    v_exp_f32 v46, v46
    v_exp_f32 v47, v47
    v_exp_f32 v48, v48
    v_exp_f32 v49, v49
    v_exp_f32 v50, v50
    v_exp_f32 v51, v51
    s_nop 0
    v_cvt_pk_bf16_f32 v68, v36, v37
    v_cvt_pk_bf16_f32 v69, v38, v39
    v_cvt_pk_bf16_f32 v70, v40, v41
    v_cvt_pk_bf16_f32 v71, v42, v43
    v_cvt_pk_bf16_f32 v72, v44, v45
    v_cvt_pk_bf16_f32 v73, v46, v47
    v_cvt_pk_bf16_f32 v74, v48, v49
    v_cvt_pk_bf16_f32 v75, v50, v51
    s_nop 1
    v_mfma_f32_32x32x16_bf16 v[76:91], v[108:111], v[68:71], v[76:91]
    v_mfma_f32_32x32x16_bf16 v[76:91], v[112:115], v[72:75], v[76:91]
    s_nop 7
    buffer_load_dwordx4 v[92:95], v128, s[28:31], s20 offen offset:3072
    s_add_u32 s21, s20, 4032
    buffer_load_dwordx4 v[108:111], v129, s[28:31], s21 offen
    buffer_load_dwordx4 v[112:115], v129, s[28:31], s21 offen offset:672
    s_waitcnt vmcnt(0)
    v_mfma_f32_32x32x16_bf16 v[36:51], v[92:95], v[4:7], v[20:35]
    s_nop 9
    v_mfma_f32_32x32x8_bf16 v[36:51], v[102:103], v[16:17], v[36:51]
    s_nop 15
    v_exp_f32 v36, v36
    v_exp_f32 v37, v37
    v_exp_f32 v38, v38
    v_exp_f32 v39, v39
    v_exp_f32 v40, v40
    v_exp_f32 v41, v41
    v_exp_f32 v42, v42
    v_exp_f32 v43, v43
    v_exp_f32 v44, v44
    v_exp_f32 v45, v45
    v_exp_f32 v46, v46
    v_exp_f32 v47, v47
    v_exp_f32 v48, v48
    v_exp_f32 v49, v49
    v_exp_f32 v50, v50
    v_exp_f32 v51, v51
    s_nop 0
    v_cvt_pk_bf16_f32 v68, v36, v37
    v_cvt_pk_bf16_f32 v69, v38, v39
    v_cvt_pk_bf16_f32 v70, v40, v41
    v_cvt_pk_bf16_f32 v71, v42, v43
    v_cvt_pk_bf16_f32 v72, v44, v45
    v_cvt_pk_bf16_f32 v73, v46, v47
    v_cvt_pk_bf16_f32 v74, v48, v49
    v_cvt_pk_bf16_f32 v75, v50, v51
    s_nop 1
    v_mfma_f32_32x32x16_bf16 v[76:91], v[108:111], v[68:71], v[76:91]
    v_mfma_f32_32x32x16_bf16 v[76:91], v[112:115], v[72:75], v[76:91]
    s_nop 7
    s_add_u32 s20, s20, 10496
    s_add_u32 s46, s46, 1
    s_cmp_lt_u32 s46, 16
    s_cbranch_scc1 K2_fbB
    s_branch K2_fin
K2_bg:
    s_sub_u32 s44, s16, 8
    s_mul_i32 s46, s44, 5248
    s_add_u32 s51, s17, s46
    s_add_u32 s50, s51, 167936
    s_mul_i32 s45, s49, 20992
    s_add_u32 s45, s45, s51
    s_mov_b32 s47, 0
    s_add_u32 m0, s46, s47
    s_add_u32 s3, s45, 4096
    buffer_load_dwordx4 v128, s[28:31], s45 offen lds
    buffer_load_dwordx4 v128, s[28:31], s45 offen offset:1024 lds
    buffer_load_dwordx4 v128, s[28:31], s45 offen offset:2048 lds
    buffer_load_dwordx4 v128, s[28:31], s45 offen offset:3072 lds
    s_add_u32 m0, m0, 4096
    s_add_u32 s45, s45, 20992
    buffer_load_dwordx4 v128, s[28:31], s3 offen lds
    s_mov_b64 exec, 0xff
    buffer_load_dwordx4 v128, s[28:31], s3 offen offset:1024 lds
    s_mov_b64 exec, -1
    s_cmp_eq_u32 s45, s50
    s_cselect_b32 s45, s51, s45
    s_add_u32 s47, s47, 20992
    s_cmp_eq_u32 s47, 83968
    s_cselect_b32 s47, 0, s47
    s_setprio 0
    s_load_dwordx4 s[4:7], s[0:1], 32
    s_load_dwordx2 s[8:9], s[0:1], 0
    s_load_dwordx2 s[32:33], s[0:1], 64
    s_mov_b32 s53, 0
    s_mov_b32 s54, 1
    s_lshl_b32 s3, s44, 2
    s_add_u32 s3, s3, 83968
    v_mov_b32 v122, s3
    v_and_b32 v121, 7, v0
    v_lshlrev_b32 v121, 8, v121
    v_add_u32 v121, 84224, v121
    v_and_b32 v1, 31, v0
    v_lshrrev_b32 v2, 5, v0
    s_add_u32 s53, s53, 1
    v_mov_b32 v123, s53
    s_waitcnt vmcnt(0)
    s_mov_b64 exec, 1
    ds_write_b32 v122, v123
    s_mov_b64 exec, -1
    s_waitcnt lgkmcnt(0)
    s_barrier
    s_add_u32 m0, s46, s47
    s_add_u32 s3, s45, 4096
    buffer_load_dwordx4 v128, s[28:31], s45 offen lds
    buffer_load_dwordx4 v128, s[28:31], s45 offen offset:1024 lds
    buffer_load_dwordx4 v128, s[28:31], s45 offen offset:2048 lds
    buffer_load_dwordx4 v128, s[28:31], s45 offen offset:3072 lds
    s_add_u32 m0, m0, 4096
    s_add_u32 s45, s45, 20992
    buffer_load_dwordx4 v128, s[28:31], s3 offen lds
    s_mov_b64 exec, 0xff
    buffer_load_dwordx4 v128, s[28:31], s3 offen offset:1024 lds
    s_mov_b64 exec, -1
    s_cmp_eq_u32 s45, s50
    s_cselect_b32 s45, s51, s45
    s_add_u32 s47, s47, 20992
    s_cmp_eq_u32 s47, 83968
    s_cselect_b32 s47, 0, s47
    s_add_u32 m0, s46, s47
    s_add_u32 s3, s45, 4096
    buffer_load_dwordx4 v128, s[28:31], s45 offen lds
    buffer_load_dwordx4 v128, s[28:31], s45 offen offset:1024 lds
    buffer_load_dwordx4 v128, s[28:31], s45 offen offset:2048 lds
    buffer_load_dwordx4 v128, s[28:31], s45 offen offset:3072 lds
    s_add_u32 m0, m0, 4096
    s_add_u32 s45, s45, 20992
    buffer_load_dwordx4 v128, s[28:31], s3 offen lds
    s_mov_b64 exec, 0xff
    buffer_load_dwordx4 v128, s[28:31], s3 offen offset:1024 lds
    s_mov_b64 exec, -1
    s_cmp_eq_u32 s45, s50
    s_cselect_b32 s45, s51, s45
    s_add_u32 s47, s47, 20992
    s_cmp_eq_u32 s47, 83968
    s_cselect_b32 s47, 0, s47
    s_add_u32 m0, s46, s47
    s_add_u32 s3, s45, 4096
    buffer_load_dwordx4 v128, s[28:31], s45 offen lds
    buffer_load_dwordx4 v128, s[28:31], s45 offen offset:1024 lds
    buffer_load_dwordx4 v128, s[28:31], s45 offen offset:2048 lds
    buffer_load_dwordx4 v128, s[28:31], s45 offen offset:3072 lds
    s_add_u32 m0, m0, 4096
    s_add_u32 s45, s45, 20992
    buffer_load_dwordx4 v128, s[28:31], s3 offen lds
    s_mov_b64 exec, 0xff
    buffer_load_dwordx4 v128, s[28:31], s3 offen offset:1024 lds
    s_mov_b64 exec, -1
    s_cmp_eq_u32 s45, s50
    s_cselect_b32 s45, s51, s45
    s_add_u32 s47, s47, 20992
    s_cmp_eq_u32 s47, 83968
    s_cselect_b32 s47, 0, s47
    s_cmp_ge_u32 s19, 24
    s_cbranch_scc1 K2_side
    s_cmp_ge_u32 s19, 11
    s_cselect_b32 s20, 1, 0
    s_mul_i32 s3, s20, 11
    s_sub_u32 s21, s19, s3
    s_lshr_b32 s22, s18, 1
    s_add_u32 s22, s22, s49
    s_sub_u32 s3, 15, s22
    s_cmp_eq_u32 s20, 1
    s_cselect_b32 s20, s3, s22
    s_cmp_lt_u32 s19, 22
    s_cbranch_scc1 K2_fn
    s_mov_b32 s20, 16
    s_sub_u32 s21, s19, 22
    s_lshl_b32 s21, s21, 3
    s_add_u32 s21, s21, s18
    s_cmp_lt_u32 s21, 11
    s_cbranch_scc1 K2_fn
K2_idle0:
    s_add_u32 s53, s53, 1
    v_mov_b32 v123, s53
    s_waitcnt vmcnt(12)
    s_mov_b64 exec, 1
    ds_write_b32 v122, v123
    s_mov_b64 exec, -1
    s_add_u32 s53, s53, 1
    v_mov_b32 v123, s53
    s_waitcnt vmcnt(6)
    s_mov_b64 exec, 1
    ds_write_b32 v122, v123
    s_mov_b64 exec, -1
    s_add_u32 s53, s53, 1
    v_mov_b32 v123, s53
    s_waitcnt vmcnt(0)
    s_mov_b64 exec, 1
    ds_write_b32 v122, v123
    s_mov_b64 exec, -1
K2_idle:
    s_branch K2_sp1b
K2_sp1a:
    s_sleep 4
K2_sp1b:
    ds_read_b32 v124, v121
    s_waitcnt lgkmcnt(0)
    v_cmp_le_u32 vcc, s54, v124
    s_nop 1
    s_cmp_eq_u64 vcc, -1
    s_cbranch_scc0 K2_sp1a
    s_add_u32 s54, s54, 1
    s_add_u32 m0, s46, s47
    s_add_u32 s3, s45, 4096
    buffer_load_dwordx4 v128, s[28:31], s45 offen lds
    buffer_load_dwordx4 v128, s[28:31], s45 offen offset:1024 lds
    buffer_load_dwordx4 v128, s[28:31], s45 offen offset:2048 lds
    buffer_load_dwordx4 v128, s[28:31], s45 offen offset:3072 lds
    s_add_u32 m0, m0, 4096
    s_add_u32 s45, s45, 20992
    buffer_load_dwordx4 v128, s[28:31], s3 offen lds
    s_mov_b64 exec, 0xff
    buffer_load_dwordx4 v128, s[28:31], s3 offen offset:1024 lds
    s_mov_b64 exec, -1
    s_cmp_eq_u32 s45, s50
    s_cselect_b32 s45, s51, s45
    s_add_u32 s47, s47, 20992
    s_cmp_eq_u32 s47, 83968
    s_cselect_b32 s47, 0, s47
    s_add_u32 s53, s53, 1
    v_mov_b32 v123, s53
    s_waitcnt vmcnt(0)
    s_mov_b64 exec, 1
    ds_write_b32 v122, v123
    s_mov_b64 exec, -1
    s_cmp_lt_u32 s53, 8
    s_cbranch_scc1 K2_idle
    s_cmp_lg_u32 s19, 24
    s_cbranch_scc1 K2_nowb
    s_cmp_lg_u32 s44, 0
    s_cbranch_scc1 K2_nowb
    s_mov_b32 s54, 7
    s_branch K2_sp2b
K2_sp2a:
    s_sleep 4
K2_sp2b:
    ds_read_b32 v124, v121
    s_waitcnt lgkmcnt(0)
    v_cmp_le_u32 vcc, s54, v124
    s_nop 1
    s_cmp_eq_u64 vcc, -1
    s_cbranch_scc0 K2_sp2a
    s_add_u32 s54, s54, 1
    buffer_wbl2 sc1
    s_waitcnt vmcnt(0)
K2_nowb:
    s_endpgm
K2_fn:
    s_and_b32 s22, s44, 1
    s_lshr_b32 s23, s44, 1
    s_lshl_b32 s24, s20, 6
    s_add_u32 s24, s24, s23
    v_lshl_add_u32 v3, v1, 1, s24
    v_lshlrev_b32 v4, 12, v3
    v_lshl_add_u32 v4, v2, 6, v4
    s_lshl_b32 s25, s21, 15
    s_mul_i32 s3, s22, 720896
    s_add_u32 s25, s25, s3
    s_mul_i32 s3, s23, 360448
    s_add_u32 s25, s25, s3
    s_add_u32 s25, s25, 7999488
    s_mov_b32 s26, 0
    s_lshl_b32 s27, s21, 7
    s_mul_i32 s3, s22, 1408
    s_add_u32 s27, s27, s3
    s_add_u32 s27, s27, 9441280
    v_lshlrev_b32 v5, 4, v2
    v_add_u32 v6, s22, v0
    v_lshlrev_b32 v6, 31, v6
    s_cmp_eq_u32 s22, 1
    s_cselect_b64 s[36:37], s[6:7], s[4:5]
    s_cmp_eq_u32 s22, s23
    s_cselect_b64 s[34:35], -1, 0
    s_mov_b32 s38, 8388608
    s_mov_b32 s39, 0x20000
    s_mov_b32 s48, 1
    s_add_u32 s53, s53, 1
    v_mov_b32 v123, s53
    s_waitcnt vmcnt(12)
    s_mov_b64 exec, 1
    ds_write_b32 v122, v123
    s_mov_b64 exec, -1
    s_add_u32 s53, s53, 1
    v_mov_b32 v123, s53
    s_waitcnt vmcnt(6)
    s_mov_b64 exec, 1
    ds_write_b32 v122, v123
    s_mov_b64 exec, -1
    s_add_u32 s53, s53, 1
    v_mov_b32 v123, s53
    s_waitcnt vmcnt(0)
    s_mov_b64 exec, 1
    ds_write_b32 v122, v123
    s_mov_b64 exec, -1
    buffer_load_dwordx4 v[104:107], v5, s[28:31], s27 offen offset:0
    buffer_load_dwordx4 v[108:111], v5, s[28:31], s27 offen offset:32
    buffer_load_dwordx4 v[112:115], v5, s[28:31], s27 offen offset:64
    buffer_load_dwordx4 v[116:119], v5, s[28:31], s27 offen offset:96
    buffer_load_dwordx4 v[56:59], v4, s[36:39], s26 offen offset:0
    buffer_load_dwordx4 v[60:63], v4, s[36:39], s26 offen offset:16
    buffer_load_dwordx4 v[64:67], v4, s[36:39], s26 offen offset:32
    buffer_load_dwordx4 v[68:71], v4, s[36:39], s26 offen offset:48
    buffer_load_dwordx4 v[8:11], v128, s[28:31], s25 offen offset:0
    buffer_load_dwordx4 v[12:15], v128, s[28:31], s25 offen offset:1024
    buffer_load_dwordx4 v[16:19], v128, s[28:31], s25 offen offset:2048
    buffer_load_dwordx4 v[20:23], v128, s[28:31], s25 offen offset:3072
    s_add_u32 s25, s25, 4096
    s_add_u32 s26, s26, 128
    s_waitcnt vmcnt(8)
    v_xor_b32 v104, v104, v6
    v_xor_b32 v105, v105, v6
    v_xor_b32 v106, v106, v6
    v_xor_b32 v107, v107, v6
    v_xor_b32 v108, v108, v6
    v_xor_b32 v109, v109, v6
    v_xor_b32 v110, v110, v6
    v_xor_b32 v111, v111, v6
    v_xor_b32 v112, v112, v6
    v_xor_b32 v113, v113, v6
    v_xor_b32 v114, v114, v6
    v_xor_b32 v115, v115, v6
    v_xor_b32 v116, v116, v6
    v_xor_b32 v117, v117, v6
    v_xor_b32 v118, v118, v6
    v_xor_b32 v119, v119, v6
    v_cndmask_b32 v104, 0, v104, s[34:35]
    v_cndmask_b32 v105, 0, v105, s[34:35]
    v_cndmask_b32 v106, 0, v106, s[34:35]
    v_cndmask_b32 v107, 0, v107, s[34:35]
    v_cndmask_b32 v108, 0, v108, s[34:35]
    v_cndmask_b32 v109, 0, v109, s[34:35]
    v_cndmask_b32 v110, 0, v110, s[34:35]
    v_cndmask_b32 v111, 0, v111, s[34:35]
    v_cndmask_b32 v112, 0, v112, s[34:35]
    v_cndmask_b32 v113, 0, v113, s[34:35]
    v_cndmask_b32 v114, 0, v114, s[34:35]
    v_cndmask_b32 v115, 0, v115, s[34:35]
    v_cndmask_b32 v116, 0, v116, s[34:35]
    v_cndmask_b32 v117, 0, v117, s[34:35]
    v_cndmask_b32 v118, 0, v118, s[34:35]
    v_cndmask_b32 v119, 0, v119, s[34:35]
    s_nop 1
K2_fnloop:
    s_waitcnt vmcnt(0)
    v_mfma_f32_32x32x16_bf16 v[104:119], v[8:11], v[56:59], v[104:119]
    v_mfma_f32_32x32x16_bf16 v[104:119], v[12:15], v[60:63], v[104:119]
    v_mfma_f32_32x32x16_bf16 v[104:119], v[16:19], v[64:67], v[104:119]
    v_mfma_f32_32x32x16_bf16 v[104:119], v[20:23], v[68:71], v[104:119]
    s_cmp_eq_u32 s48, 8
    s_cbranch_scc1 K2_fn3
    s_add_u32 s48, s48, 1
    s_cmp_ge_u32 s53, 8
    s_cbranch_scc1 K2_fn2
    s_branch K2_sp3b
K2_sp3a:
    s_sleep 4
K2_sp3b:
    ds_read_b32 v124, v121
    s_waitcnt lgkmcnt(0)
    v_cmp_le_u32 vcc, s54, v124
    s_nop 1
    s_cmp_eq_u64 vcc, -1
    s_cbranch_scc0 K2_sp3a
    s_add_u32 s54, s54, 1
    s_add_u32 m0, s46, s47
    s_add_u32 s3, s45, 4096
    buffer_load_dwordx4 v128, s[28:31], s45 offen lds
    buffer_load_dwordx4 v128, s[28:31], s45 offen offset:1024 lds
    buffer_load_dwordx4 v128, s[28:31], s45 offen offset:2048 lds
    buffer_load_dwordx4 v128, s[28:31], s45 offen offset:3072 lds
    s_add_u32 m0, m0, 4096
    s_add_u32 s45, s45, 20992
    buffer_load_dwordx4 v128, s[28:31], s3 offen lds
    s_mov_b64 exec, 0xff
    buffer_load_dwordx4 v128, s[28:31], s3 offen offset:1024 lds
    s_mov_b64 exec, -1
    s_cmp_eq_u32 s45, s50
    s_cselect_b32 s45, s51, s45
    s_add_u32 s47, s47, 20992
    s_cmp_eq_u32 s47, 83968
    s_cselect_b32 s47, 0, s47
    buffer_load_dwordx4 v[56:59], v4, s[36:39], s26 offen offset:0
    buffer_load_dwordx4 v[60:63], v4, s[36:39], s26 offen offset:16
    buffer_load_dwordx4 v[64:67], v4, s[36:39], s26 offen offset:32
    buffer_load_dwordx4 v[68:71], v4, s[36:39], s26 offen offset:48
    buffer_load_dwordx4 v[8:11], v128, s[28:31], s25 offen offset:0
    buffer_load_dwordx4 v[12:15], v128, s[28:31], s25 offen offset:1024
    buffer_load_dwordx4 v[16:19], v128, s[28:31], s25 offen offset:2048
    buffer_load_dwordx4 v[20:23], v128, s[28:31], s25 offen offset:3072
    s_add_u32 s25, s25, 4096
    s_add_u32 s26, s26, 128
    s_add_u32 s53, s53, 1
    v_mov_b32 v123, s53
    s_waitcnt vmcnt(8)
    s_mov_b64 exec, 1
    ds_write_b32 v122, v123
    s_mov_b64 exec, -1
    s_branch K2_fnloop
K2_fn2:
    buffer_load_dwordx4 v[56:59], v4, s[36:39], s26 offen offset:0
    buffer_load_dwordx4 v[60:63], v4, s[36:39], s26 offen offset:16
    buffer_load_dwordx4 v[64:67], v4, s[36:39], s26 offen offset:32
    buffer_load_dwordx4 v[68:71], v4, s[36:39], s26 offen offset:48
    buffer_load_dwordx4 v[8:11], v128, s[28:31], s25 offen offset:0
    buffer_load_dwordx4 v[12:15], v128, s[28:31], s25 offen offset:1024
    buffer_load_dwordx4 v[16:19], v128, s[28:31], s25 offen offset:2048
    buffer_load_dwordx4 v[20:23], v128, s[28:31], s25 offen offset:3072
    s_add_u32 s25, s25, 4096
    s_add_u32 s26, s26, 128
    s_branch K2_fnloop
K2_fn3:
    s_mov_b32 s34, 0
    s_mov_b32 s35, 0
    s_cmp_eq_u32 s21, 0
    s_cselect_b32 s34, -1, s34
    s_cmp_eq_u32 s21, 10
    s_cselect_b32 s34, -1, s34
    s_cmp_eq_u32 s22, 0
    s_cselect_b32 s34, 0, s34
    v_mul_u32_u24 v3, 1408, v3
    v_lshl_add_u32 v3, v2, 4, v3
    s_lshl_b32 s3, s21, 7
    s_mul_i32 s25, s22, 1531904
    s_add_u32 s25, s25, s3
    s_add_u32 s25, s25, 9453568
    s_nop 7
    v_cndmask_b32 v104, v104, 0, s[34:35]
    buffer_store_dwordx4 v[104:107], v3, s[28:31], s25 offen offset:0
    buffer_store_dwordx4 v[108:111], v3, s[28:31], s25 offen offset:32
    buffer_store_dwordx4 v[112:115], v3, s[28:31], s25 offen offset:64
    buffer_store_dwordx4 v[116:119], v3, s[28:31], s25 offen offset:96
    s_endpgm
K2_side:
    s_setprio 3
    s_sub_u32 s20, s19, 24
    s_lshl_b32 s20, s20, 3
    s_add_u32 s20, s20, s18
    s_lshl_b32 s20, s20, 2
    s_add_u32 s20, s20, s44
    v_and_b32 v1, 15, v0
    v_lshrrev_b32 v2, 4, v0
    v_lshlrev_b32 v3, 4, v1
    s_lshl_b32 s3, s20, 3
    v_add_u32 v4, s3, v2
    v_mul_u32_u24 v5, 1280, v4
    v_add_u32 v5, v5, v3
    v_lshlrev_b32 v4, 2, v4
    s_mov_b32 s36, s8
    s_mov_b32 s37, s9
    s_mov_b32 s38, 2621440
    s_mov_b32 s39, 0x20000
    s_mov_b32 s56, s32
    s_mov_b32 s57, s33
    s_mov_b32 s58, 1280
    s_mov_b32 s59, 0x20000
    s_mov_b32 s21, 5120
    s_add_u32 s53, s53, 1
    v_mov_b32 v123, s53
    s_waitcnt vmcnt(12)
    s_mov_b64 exec, 1
    ds_write_b32 v122, v123
    s_mov_b64 exec, -1
    s_add_u32 s53, s53, 1
    v_mov_b32 v123, s53
    s_waitcnt vmcnt(6)
    s_mov_b64 exec, 1
    ds_write_b32 v122, v123
    s_mov_b64 exec, -1
    s_add_u32 s53, s53, 1
    v_mov_b32 v123, s53
    s_waitcnt vmcnt(0)
    s_mov_b64 exec, 1
    ds_write_b32 v122, v123
    s_mov_b64 exec, -1
    buffer_load_dwordx4 v[8:11], v3, s[56:59], 0 offen offset:0
    buffer_load_dwordx4 v[12:15], v3, s[56:59], 0 offen offset:256
    buffer_load_dwordx4 v[16:19], v3, s[56:59], 0 offen offset:512
    buffer_load_dwordx4 v[20:23], v3, s[56:59], 0 offen offset:768
    buffer_load_dwordx4 v[24:27], v3, s[56:59], 0 offen offset:1024
    buffer_load_dwordx4 v[28:31], v5, s[36:39], 0 offen offset:0
    buffer_load_dwordx4 v[32:35], v5, s[36:39], 0 offen offset:256
    buffer_load_dwordx4 v[36:39], v5, s[36:39], 0 offen offset:512
    buffer_load_dwordx4 v[40:43], v5, s[36:39], 0 offen offset:768
    buffer_load_dwordx4 v[44:47], v5, s[36:39], 0 offen offset:1024
    buffer_load_dwordx4 v[48:51], v5, s[36:39], s21 offen offset:0
    buffer_load_dwordx4 v[52:55], v5, s[36:39], s21 offen offset:256
    buffer_load_dwordx4 v[56:59], v5, s[36:39], s21 offen offset:512
    buffer_load_dwordx4 v[60:63], v5, s[36:39], s21 offen offset:768
    buffer_load_dwordx4 v[64:67], v5, s[36:39], s21 offen offset:1024
    v_mov_b32 v70, 0
    v_mov_b32 v71, 0
    s_waitcnt vmcnt(0)
    v_dot2_f32_bf16 v70, v28, v8, v70
    v_dot2_f32_bf16 v71, v48, v8, v71
    v_dot2_f32_bf16 v70, v29, v9, v70
    v_dot2_f32_bf16 v71, v49, v9, v71
    v_dot2_f32_bf16 v70, v30, v10, v70
    v_dot2_f32_bf16 v71, v50, v10, v71
    v_dot2_f32_bf16 v70, v31, v11, v70
    v_dot2_f32_bf16 v71, v51, v11, v71
    v_dot2_f32_bf16 v70, v32, v12, v70
    v_dot2_f32_bf16 v71, v52, v12, v71
    v_dot2_f32_bf16 v70, v33, v13, v70
    v_dot2_f32_bf16 v71, v53, v13, v71
    v_dot2_f32_bf16 v70, v34, v14, v70
    v_dot2_f32_bf16 v71, v54, v14, v71
    v_dot2_f32_bf16 v70, v35, v15, v70
    v_dot2_f32_bf16 v71, v55, v15, v71
    v_dot2_f32_bf16 v70, v36, v16, v70
    v_dot2_f32_bf16 v71, v56, v16, v71
    v_dot2_f32_bf16 v70, v37, v17, v70
    v_dot2_f32_bf16 v71, v57, v17, v71
    v_dot2_f32_bf16 v70, v38, v18, v70
    v_dot2_f32_bf16 v71, v58, v18, v71
    v_dot2_f32_bf16 v70, v39, v19, v70
    v_dot2_f32_bf16 v71, v59, v19, v71
    v_dot2_f32_bf16 v70, v40, v20, v70
    v_dot2_f32_bf16 v71, v60, v20, v71
    v_dot2_f32_bf16 v70, v41, v21, v70
    v_dot2_f32_bf16 v71, v61, v21, v71
    v_dot2_f32_bf16 v70, v42, v22, v70
    v_dot2_f32_bf16 v71, v62, v22, v71
    v_dot2_f32_bf16 v70, v43, v23, v70
    v_dot2_f32_bf16 v71, v63, v23, v71
    v_dot2_f32_bf16 v70, v44, v24, v70
    v_dot2_f32_bf16 v71, v64, v24, v71
    v_dot2_f32_bf16 v70, v45, v25, v70
    v_dot2_f32_bf16 v71, v65, v25, v71
    v_dot2_f32_bf16 v70, v46, v26, v70
    v_dot2_f32_bf16 v71, v66, v26, v71
    v_dot2_f32_bf16 v70, v47, v27, v70
    v_dot2_f32_bf16 v71, v67, v27, v71
    s_nop 3
    v_add_f32_dpp v70, v70, v70 row_ror:8 row_mask:0xf bank_mask:0xf
    v_add_f32_dpp v71, v71, v71 row_ror:8 row_mask:0xf bank_mask:0xf
    s_nop 1
    v_add_f32_dpp v70, v70, v70 row_ror:4 row_mask:0xf bank_mask:0xf
    v_add_f32_dpp v71, v71, v71 row_ror:4 row_mask:0xf bank_mask:0xf
    s_nop 1
    v_add_f32_dpp v70, v70, v70 row_ror:2 row_mask:0xf bank_mask:0xf
    v_add_f32_dpp v71, v71, v71 row_ror:2 row_mask:0xf bank_mask:0xf
    s_nop 1
    v_add_f32_dpp v70, v70, v70 row_ror:1 row_mask:0xf bank_mask:0xf
    v_add_f32_dpp v71, v71, v71 row_ror:1 row_mask:0xf bank_mask:0xf
    s_nop 1
    v_mul_f32 v70, 3216550459, v70
    v_mul_f32 v71, 3216550459, v71
    v_exp_f32 v70, v70
    v_exp_f32 v71, v71
    s_nop 0
    v_add_f32 v70, 1.0, v70
    v_add_f32 v71, 1.0, v71
    v_rcp_f32 v70, v70
    v_rcp_f32 v71, v71
    s_mov_b32 s34, 0x00010001
    s_mov_b32 s35, 0x00010001
    s_mov_b32 s3, 9445376
    s_mov_b64 exec, s[34:35]
    buffer_store_dword v70, v4, s[28:31], s3 offen
    buffer_store_dword v71, v4, s[28:31], s3 offen offset:16
    s_mov_b64 exec, -1
    s_sub_u32 s3, s19, 24
    s_lshl_b32 s3, s3, 2
    s_add_u32 s3, s3, s44
    s_mul_i32 s3, s3, 25600
    s_add_u32 s3, s3, 15138816
    v_lshlrev_b32 v7, 7, v0
    v_min_u32 v8, 7, v0
    v_lshlrev_b32 v8, 7, v8
    buffer_load_dword v130, v7, s[28:31], s3 offen
    s_add_u32 s3, s3, 8192
    buffer_load_dword v130, v7, s[28:31], s3 offen
    s_add_u32 s3, s3, 8192
    buffer_load_dword v130, v7, s[28:31], s3 offen
    s_add_u32 s3, s3, 8192
    buffer_load_dword v130, v8, s[28:31], s3 offen
    s_setprio 0
    s_branch K2_idle
K2_end:
    s_endpgm
.globl k3_kernel
.p2align 8
.type k3_kernel,@function
k3_kernel:
    s_cmp_ge_u32 s2, 256
    s_cbranch_scc1 K3_end
    s_load_dwordx2 s[12:13], s[0:1], 88
    s_load_dwordx2 s[10:11], s[0:1], 72
    s_getpc_b64 s[84:85]
K3_pc:
    v_lshlrev_b32 v4, 7, v0
    v_min_u32 v4, TEXT_END-K3_pc-4, v4
    global_load_dword v253, v4, s[84:85]
    v_lshrrev_b32 v1, 6, v0
    v_and_b32 v0, 63, v0
    s_and_b32 s18, s2, 7
    s_lshr_b32 s19, s2, 3
    v_readfirstlane_b32 s16, v1
    s_and_b32 s14, s19, 3
    s_lshr_b32 s3, s18, 1
    s_lshl_b32 s3, s3, 2
    s_add_u32 s14, s14, s3
    s_and_b32 s3, s18, 1
    s_lshl_b32 s3, s3, 4
    s_add_u32 s14, s14, s3
    s_lshr_b32 s15, s19, 2
    v_lshlrev_b32 v2, 4, v0
    v_add_u32 v3, 4096, v2
    s_mov_b32 s30, 268435456
    s_mov_b32 s31, 0x20000
    s_mul_i32 s17, s16, 5120
    s_mul_i32 s20, s14, 81920
    s_add_u32 s20, s20, s17
    s_add_u32 s20, s20, 12517376
    s_add_u32 s3, s16, 0
    s_and_b32 s36, s3, 3
    s_mul_i32 s3, s36, 20480
    s_add_u32 s32, s20, s3
    s_add_u32 s3, s16, 1
    s_and_b32 s37, s3, 3
    s_mul_i32 s3, s37, 20480
    s_add_u32 s33, s20, s3
    s_add_u32 s3, s16, 2
    s_and_b32 s38, s3, 3
    s_mul_i32 s3, s38, 20480
    s_add_u32 s34, s20, s3
    s_add_u32 s3, s16, 3
    s_and_b32 s39, s3, 3
    s_mul_i32 s3, s39, 20480
    s_add_u32 s35, s20, s3
    s_mul_i32 s40, s15, 102400
    s_add_u32 s40, s40, s17
    s_add_u32 s40, s40, 15138816
    s_add_u32 s41, s40, 20480
    s_add_u32 s42, s40, 40960
    s_add_u32 s43, s40, 61440
    s_add_u32 s44, s40, 81920
    s_waitcnt lgkmcnt(0)
    s_mov_b32 s28, s12
    s_mov_b32 s29, s13
    buffer_load_dwordx4 v[32:35], v2, s[28:31], s32 offen offset:0
    buffer_load_dwordx4 v[112:115], v2, s[28:31], s40 offen offset:0
    buffer_load_dwordx4 v[36:39], v2, s[28:31], s33 offen offset:0
    buffer_load_dwordx4 v[116:119], v2, s[28:31], s41 offen offset:0
    buffer_load_dwordx4 v[40:43], v2, s[28:31], s34 offen offset:0
    buffer_load_dwordx4 v[120:123], v2, s[28:31], s42 offen offset:0
    buffer_load_dwordx4 v[44:47], v2, s[28:31], s35 offen offset:0
    buffer_load_dwordx4 v[124:127], v2, s[28:31], s43 offen offset:0
    buffer_load_dwordx4 v[128:131], v2, s[28:31], s44 offen offset:0
    buffer_load_dwordx4 v[48:51], v2, s[28:31], s32 offen offset:1024
    buffer_load_dwordx4 v[132:135], v2, s[28:31], s40 offen offset:1024
    buffer_load_dwordx4 v[52:55], v2, s[28:31], s33 offen offset:1024
    buffer_load_dwordx4 v[136:139], v2, s[28:31], s41 offen offset:1024
    buffer_load_dwordx4 v[56:59], v2, s[28:31], s34 offen offset:1024
    buffer_load_dwordx4 v[140:143], v2, s[28:31], s42 offen offset:1024
    buffer_load_dwordx4 v[60:63], v2, s[28:31], s35 offen offset:1024
    buffer_load_dwordx4 v[144:147], v2, s[28:31], s43 offen offset:1024
    buffer_load_dwordx4 v[148:151], v2, s[28:31], s44 offen offset:1024
    buffer_load_dwordx4 v[64:67], v2, s[28:31], s32 offen offset:2048
    buffer_load_dwordx4 v[152:155], v2, s[28:31], s40 offen offset:2048
    buffer_load_dwordx4 v[68:71], v2, s[28:31], s33 offen offset:2048
    buffer_load_dwordx4 v[156:159], v2, s[28:31], s41 offen offset:2048
    buffer_load_dwordx4 v[72:75], v2, s[28:31], s34 offen offset:2048
    buffer_load_dwordx4 v[160:163], v2, s[28:31], s42 offen offset:2048
    buffer_load_dwordx4 v[76:79], v2, s[28:31], s35 offen offset:2048
    buffer_load_dwordx4 v[164:167], v2, s[28:31], s43 offen offset:2048
    buffer_load_dwordx4 v[168:171], v2, s[28:31], s44 offen offset:2048
    v_and_b32 v4, 15, v0
    v_lshrrev_b32 v5, 4, v0
    s_lshl_b32 s3, s14, 4
    v_add_u32 v6, s3, v4
    s_and_b32 s21, s16, 1
    s_cmp_eq_u32 s21, 1
    s_cselect_b64 s[22:23], -1, 0
    v_sub_u32 v7, 1024, v6
    v_cndmask_b32 v7, v6, v7, s[22:23]
    s_cmp_ge_u32 s16, 2
    s_cselect_b64 s[26:27], -1, 0
    v_cmp_eq_u32 vcc, 0, v6
    s_and_b64 s[24:25], vcc, s[26:27]
    v_mov_b32 v8, 512
    v_cndmask_b32 v7, v7, v8, s[24:25]
    s_andn2_b64 s[24:25], s[24:25], s[22:23]
    s_andn2_b64 s[26:27], s[26:27], s[24:25]
    v_sub_u32 v8, 2048, v7
    v_cndmask_b32 v8, v7, v8, s[26:27]
    s_cmp_ge_u32 s15, 4
    s_cselect_b64 s[22:23], -1, 0
    s_xor_b64 s[26:27], s[26:27], s[22:23]
    v_mov_b32 v9, -1.0
    v_mov_b32 v10, 1.0
    v_cndmask_b32 v24, v9, v10, s[26:27]
    v_mul_u32_u24 v9, 1408, v7
    s_mov_b32 s51, 9453568
    s_mov_b32 s52, 10985472
    s_mul_i32 s21, s15, 80
    v_lshl_add_u32 v10, v5, 2, s21
    s_mov_b32 s46, 0
    s_mov_b32 s47, 4
    s_cmp_ge_u32 s15, 4
    s_cselect_b32 s46, 2548, s46
    s_cselect_b32 s47, -4, s47
    v_add_u32 v9, s46, v9
    v_mad_i32_i24 v12, v10, s47, v9
    s_mul_i32 s48, s47, 16
    v_add_u32 v13, s48, v12
    v_add_u32 v14, s48, v13
    v_add_u32 v15, s48, v14
    v_add_u32 v16, s48, v15
    v_lshlrev_b32 v17, 2, v8
    s_mov_b32 s53, 9445376
    v_mul_u32_u24 v18, 1280, v8
    v_lshl_add_u32 v19, v10, 1, v18
    v_and_b32 v11, 1, v5
    v_mul_u32_u24 v11, 24, v11
    v_add_u32 v18, v19, v11
    s_mov_b32 s4, s10
    s_mov_b32 s5, s11
    s_mov_b32 s6, 2621440
    s_mov_b32 s7, 0x20000
    s_mul_i32 s3, s37, 15360
    s_add_u32 s3, s3, 0
    v_add_u32 v21, s3, v2
    s_mul_i32 s3, s38, 15360
    s_add_u32 s3, s3, 5120
    v_add_u32 v22, s3, v2
    s_mul_i32 s3, s39, 15360
    s_add_u32 s3, s3, 10240
    v_add_u32 v23, s3, v2
    s_mul_i32 s3, s16, 15360
    v_add_u32 v20, s3, v2
    s_waitcnt vmcnt(18)
    v_mfma_f32_16x16x32_bf16 a[20:23], v[112:115], v[36:39], 0
    v_mfma_f32_16x16x32_bf16 a[24:27], v[116:119], v[36:39], 0
    buffer_load_dwordx4 v[80:83], v2, s[28:31], s32 offen offset:3072
    v_mfma_f32_16x16x32_bf16 a[28:31], v[120:123], v[36:39], 0
    v_mfma_f32_16x16x32_bf16 a[32:35], v[124:127], v[36:39], 0
    buffer_load_dwordx4 v[172:175], v2, s[28:31], s40 offen offset:3072
    v_mfma_f32_16x16x32_bf16 a[36:39], v[128:131], v[36:39], 0
    v_mfma_f32_16x16x32_bf16 a[40:43], v[112:115], v[40:43], 0
    buffer_load_dwordx4 v[84:87], v2, s[28:31], s33 offen offset:3072
    v_mfma_f32_16x16x32_bf16 a[44:47], v[116:119], v[40:43], 0
    v_mfma_f32_16x16x32_bf16 a[48:51], v[120:123], v[40:43], 0
    buffer_load_dwordx4 v[176:179], v2, s[28:31], s41 offen offset:3072
    v_mfma_f32_16x16x32_bf16 a[52:55], v[124:127], v[40:43], 0
    v_mfma_f32_16x16x32_bf16 a[56:59], v[128:131], v[40:43], 0
    buffer_load_dwordx4 v[88:91], v2, s[28:31], s34 offen offset:3072
    v_mfma_f32_16x16x32_bf16 a[60:63], v[112:115], v[44:47], 0
    v_mfma_f32_16x16x32_bf16 a[64:67], v[116:119], v[44:47], 0
    buffer_load_dwordx4 v[180:183], v2, s[28:31], s42 offen offset:3072
    v_mfma_f32_16x16x32_bf16 a[68:71], v[120:123], v[44:47], 0
    v_mfma_f32_16x16x32_bf16 a[72:75], v[124:127], v[44:47], 0
    buffer_load_dwordx4 v[92:95], v2, s[28:31], s35 offen offset:3072
    v_mfma_f32_16x16x32_bf16 a[76:79], v[128:131], v[44:47], 0
    v_mfma_f32_16x16x32_bf16 a[0:3], v[112:115], v[32:35], 0
    buffer_load_dwordx4 v[184:187], v2, s[28:31], s43 offen offset:3072
    v_mfma_f32_16x16x32_bf16 a[4:7], v[116:119], v[32:35], 0
    v_mfma_f32_16x16x32_bf16 a[8:11], v[120:123], v[32:35], 0
    buffer_load_dwordx4 v[188:191], v2, s[28:31], s44 offen offset:3072
    v_mfma_f32_16x16x32_bf16 a[12:15], v[124:127], v[32:35], 0
    v_mfma_f32_16x16x32_bf16 a[16:19], v[128:131], v[32:35], 0
    s_waitcnt vmcnt(18)
    v_mfma_f32_16x16x32_bf16 a[20:23], v[132:135], v[52:55], a[20:23]
    v_mfma_f32_16x16x32_bf16 a[24:27], v[136:139], v[52:55], a[24:27]
    buffer_load_dwordx4 v[96:99], v3, s[28:31], s32 offen offset:0
    v_mfma_f32_16x16x32_bf16 a[28:31], v[140:143], v[52:55], a[28:31]
    v_mfma_f32_16x16x32_bf16 a[32:35], v[144:147], v[52:55], a[32:35]
    buffer_load_dwordx4 v[192:195], v3, s[28:31], s40 offen offset:0
    v_mfma_f32_16x16x32_bf16 a[36:39], v[148:151], v[52:55], a[36:39]
    v_mfma_f32_16x16x32_bf16 a[40:43], v[132:135], v[56:59], a[40:43]
    buffer_load_dwordx4 v[100:103], v3, s[28:31], s33 offen offset:0
    v_mfma_f32_16x16x32_bf16 a[44:47], v[136:139], v[56:59], a[44:47]
    v_mfma_f32_16x16x32_bf16 a[48:51], v[140:143], v[56:59], a[48:51]
    buffer_load_dwordx4 v[196:199], v3, s[28:31], s41 offen offset:0
    v_mfma_f32_16x16x32_bf16 a[52:55], v[144:147], v[56:59], a[52:55]
    v_mfma_f32_16x16x32_bf16 a[56:59], v[148:151], v[56:59], a[56:59]
    buffer_load_dwordx4 v[104:107], v3, s[28:31], s34 offen offset:0
    v_mfma_f32_16x16x32_bf16 a[60:63], v[132:135], v[60:63], a[60:63]
    v_mfma_f32_16x16x32_bf16 a[64:67], v[136:139], v[60:63], a[64:67]
    buffer_load_dwordx4 v[200:203], v3, s[28:31], s42 offen offset:0
    v_mfma_f32_16x16x32_bf16 a[68:71], v[140:143], v[60:63], a[68:71]
    v_mfma_f32_16x16x32_bf16 a[72:75], v[144:147], v[60:63], a[72:75]
    buffer_load_dwordx4 v[108:111], v3, s[28:31], s35 offen offset:0
    v_mfma_f32_16x16x32_bf16 a[76:79], v[148:151], v[60:63], a[76:79]
    v_mfma_f32_16x16x32_bf16 a[0:3], v[132:135], v[48:51], a[0:3]
    buffer_load_dwordx4 v[204:207], v3, s[28:31], s43 offen offset:0
    v_mfma_f32_16x16x32_bf16 a[4:7], v[136:139], v[48:51], a[4:7]
    v_mfma_f32_16x16x32_bf16 a[8:11], v[140:143], v[48:51], a[8:11]
    buffer_load_dwordx4 v[208:211], v3, s[28:31], s44 offen offset:0
    v_mfma_f32_16x16x32_bf16 a[12:15], v[144:147], v[48:51], a[12:15]
    v_mfma_f32_16x16x32_bf16 a[16:19], v[148:151], v[48:51], a[16:19]
    s_waitcnt vmcnt(18)
    v_mfma_f32_16x16x32_bf16 a[20:23], v[152:155], v[68:71], a[20:23]
    v_mfma_f32_16x16x32_bf16 a[24:27], v[156:159], v[68:71], a[24:27]
    buffer_load_dwordx4 v[212:215], v12, s[28:31], s51 offen
    v_mfma_f32_16x16x32_bf16 a[28:31], v[160:163], v[68:71], a[28:31]
    v_mfma_f32_16x16x32_bf16 a[32:35], v[164:167], v[68:71], a[32:35]
    buffer_load_dwordx4 v[232:235], v12, s[28:31], s52 offen
    v_mfma_f32_16x16x32_bf16 a[36:39], v[168:171], v[68:71], a[36:39]
    v_mfma_f32_16x16x32_bf16 a[40:43], v[152:155], v[72:75], a[40:43]
    buffer_load_dwordx4 v[216:219], v13, s[28:31], s51 offen
    v_mfma_f32_16x16x32_bf16 a[44:47], v[156:159], v[72:75], a[44:47]
    v_mfma_f32_16x16x32_bf16 a[48:51], v[160:163], v[72:75], a[48:51]
    buffer_load_dwordx4 v[236:239], v13, s[28:31], s52 offen
    v_mfma_f32_16x16x32_bf16 a[52:55], v[164:167], v[72:75], a[52:55]
    v_mfma_f32_16x16x32_bf16 a[56:59], v[168:171], v[72:75], a[56:59]
    buffer_load_dwordx4 v[220:223], v14, s[28:31], s51 offen
    v_mfma_f32_16x16x32_bf16 a[60:63], v[152:155], v[76:79], a[60:63]
    v_mfma_f32_16x16x32_bf16 a[64:67], v[156:159], v[76:79], a[64:67]
    buffer_load_dwordx4 v[240:243], v14, s[28:31], s52 offen
    v_mfma_f32_16x16x32_bf16 a[68:71], v[160:163], v[76:79], a[68:71]
    v_mfma_f32_16x16x32_bf16 a[72:75], v[164:167], v[76:79], a[72:75]
    buffer_load_dwordx4 v[224:227], v15, s[28:31], s51 offen
    v_mfma_f32_16x16x32_bf16 a[76:79], v[168:171], v[76:79], a[76:79]
    v_mfma_f32_16x16x32_bf16 a[0:3], v[152:155], v[64:67], a[0:3]
    buffer_load_dwordx4 v[244:247], v15, s[28:31], s52 offen
    v_mfma_f32_16x16x32_bf16 a[4:7], v[156:159], v[64:67], a[4:7]
    v_mfma_f32_16x16x32_bf16 a[8:11], v[160:163], v[64:67], a[8:11]
    buffer_load_dwordx4 v[228:231], v16, s[28:31], s51 offen
    v_mfma_f32_16x16x32_bf16 a[12:15], v[164:167], v[64:67], a[12:15]
    v_mfma_f32_16x16x32_bf16 a[16:19], v[168:171], v[64:67], a[16:19]
    buffer_load_dwordx4 v[248:251], v16, s[28:31], s52 offen
    buffer_load_dword v252, v17, s[28:31], s53 offen
    s_waitcnt vmcnt(20)
    v_mfma_f32_16x16x32_bf16 a[20:23], v[172:175], v[84:87], a[20:23]
    v_mfma_f32_16x16x32_bf16 a[24:27], v[176:179], v[84:87], a[24:27]
    v_mfma_f32_16x16x32_bf16 a[28:31], v[180:183], v[84:87], a[28:31]
    v_mfma_f32_16x16x32_bf16 a[32:35], v[184:187], v[84:87], a[32:35]
    v_mfma_f32_16x16x32_bf16 a[36:39], v[188:191], v[84:87], a[36:39]
    v_mfma_f32_16x16x32_bf16 a[40:43], v[172:175], v[88:91], a[40:43]
    v_mfma_f32_16x16x32_bf16 a[44:47], v[176:179], v[88:91], a[44:47]
    v_mfma_f32_16x16x32_bf16 a[48:51], v[180:183], v[88:91], a[48:51]
    v_mfma_f32_16x16x32_bf16 a[52:55], v[184:187], v[88:91], a[52:55]
    v_mfma_f32_16x16x32_bf16 a[56:59], v[188:191], v[88:91], a[56:59]
    v_mfma_f32_16x16x32_bf16 a[60:63], v[172:175], v[92:95], a[60:63]
    v_mfma_f32_16x16x32_bf16 a[64:67], v[176:179], v[92:95], a[64:67]
    v_mfma_f32_16x16x32_bf16 a[68:71], v[180:183], v[92:95], a[68:71]
    v_mfma_f32_16x16x32_bf16 a[72:75], v[184:187], v[92:95], a[72:75]
    v_mfma_f32_16x16x32_bf16 a[76:79], v[188:191], v[92:95], a[76:79]
    v_mfma_f32_16x16x32_bf16 a[0:3], v[172:175], v[80:83], a[0:3]
    v_mfma_f32_16x16x32_bf16 a[4:7], v[176:179], v[80:83], a[4:7]
    v_mfma_f32_16x16x32_bf16 a[8:11], v[180:183], v[80:83], a[8:11]
    v_mfma_f32_16x16x32_bf16 a[12:15], v[184:187], v[80:83], a[12:15]
    v_mfma_f32_16x16x32_bf16 a[16:19], v[188:191], v[80:83], a[16:19]
    s_waitcnt vmcnt(11)
    v_mfma_f32_16x16x32_bf16 a[20:23], v[192:195], v[100:103], a[20:23]
    v_mfma_f32_16x16x32_bf16 a[24:27], v[196:199], v[100:103], a[24:27]
    v_mfma_f32_16x16x32_bf16 a[28:31], v[200:203], v[100:103], a[28:31]
    v_mfma_f32_16x16x32_bf16 a[32:35], v[204:207], v[100:103], a[32:35]
    v_mfma_f32_16x16x32_bf16 a[36:39], v[208:211], v[100:103], a[36:39]
    v_mfma_f32_16x16x32_bf16 a[40:43], v[192:195], v[104:107], a[40:43]
    v_mfma_f32_16x16x32_bf16 a[44:47], v[196:199], v[104:107], a[44:47]
    v_mfma_f32_16x16x32_bf16 a[48:51], v[200:203], v[104:107], a[48:51]
    v_mfma_f32_16x16x32_bf16 a[52:55], v[204:207], v[104:107], a[52:55]
    v_mfma_f32_16x16x32_bf16 a[56:59], v[208:211], v[104:107], a[56:59]
    ds_write_b128 v21, a[20:23] offset:0
    v_mfma_f32_16x16x32_bf16 a[60:63], v[192:195], v[108:111], a[60:63]
    ds_write_b128 v21, a[24:27] offset:1024
    v_mfma_f32_16x16x32_bf16 a[64:67], v[196:199], v[108:111], a[64:67]
    ds_write_b128 v21, a[28:31] offset:2048
    v_mfma_f32_16x16x32_bf16 a[68:71], v[200:203], v[108:111], a[68:71]
    ds_write_b128 v21, a[32:35] offset:3072
    v_mfma_f32_16x16x32_bf16 a[72:75], v[204:207], v[108:111], a[72:75]
    ds_write_b128 v21, a[36:39] offset:4096
    v_mfma_f32_16x16x32_bf16 a[76:79], v[208:211], v[108:111], a[76:79]
    ds_write_b128 v22, a[40:43] offset:0
    v_mfma_f32_16x16x32_bf16 a[0:3], v[192:195], v[96:99], a[0:3]
    ds_write_b128 v22, a[44:47] offset:1024
    v_mfma_f32_16x16x32_bf16 a[4:7], v[196:199], v[96:99], a[4:7]
    ds_write_b128 v22, a[48:51] offset:2048
    v_mfma_f32_16x16x32_bf16 a[8:11], v[200:203], v[96:99], a[8:11]
    ds_write_b128 v22, a[52:55] offset:3072
    v_mfma_f32_16x16x32_bf16 a[12:15], v[204:207], v[96:99], a[12:15]
    ds_write_b128 v22, a[56:59] offset:4096
    v_mfma_f32_16x16x32_bf16 a[16:19], v[208:211], v[96:99], a[16:19]
    ds_write_b128 v23, a[60:63] offset:0
    ds_write_b128 v23, a[64:67] offset:1024
    ds_write_b128 v23, a[68:71] offset:2048
    ds_write_b128 v23, a[72:75] offset:3072
    ds_write_b128 v23, a[76:79] offset:4096
    s_nop 2
    v_accvgpr_read_b32 v32, a0
    v_accvgpr_read_b32 v33, a1
    v_accvgpr_read_b32 v34, a2
    v_accvgpr_read_b32 v35, a3
    v_accvgpr_read_b32 v36, a4
    v_accvgpr_read_b32 v37, a5
    v_accvgpr_read_b32 v38, a6
    v_accvgpr_read_b32 v39, a7
    v_accvgpr_read_b32 v40, a8
    v_accvgpr_read_b32 v41, a9
    v_accvgpr_read_b32 v42, a10
    v_accvgpr_read_b32 v43, a11
    v_accvgpr_read_b32 v44, a12
    v_accvgpr_read_b32 v45, a13
    v_accvgpr_read_b32 v46, a14
    v_accvgpr_read_b32 v47, a15
    v_accvgpr_read_b32 v48, a16
    v_accvgpr_read_b32 v49, a17
    v_accvgpr_read_b32 v50, a18
    v_accvgpr_read_b32 v51, a19
    s_waitcnt lgkmcnt(0)
    s_barrier
    ds_read_b128 v[52:55], v20 offset:0
    ds_read_b128 v[56:59], v20 offset:1024
    ds_read_b128 v[60:63], v20 offset:2048
    ds_read_b128 v[64:67], v20 offset:3072
    ds_read_b128 v[68:71], v20 offset:4096
    ds_read_b128 v[72:75], v20 offset:5120
    ds_read_b128 v[76:79], v20 offset:6144
    ds_read_b128 v[80:83], v20 offset:7168
    ds_read_b128 v[84:87], v20 offset:8192
    ds_read_b128 v[88:91], v20 offset:9216
    ds_read_b128 v[92:95], v20 offset:10240
    ds_read_b128 v[96:99], v20 offset:11264
    ds_read_b128 v[100:103], v20 offset:12288
    ds_read_b128 v[104:107], v20 offset:13312
    ds_read_b128 v[108:111], v20 offset:14336
    s_waitcnt vmcnt(0)
    v_fma_f32 v212, v232, v24, v212
    v_fma_f32 v213, v233, v24, v213
    v_fma_f32 v214, v234, v24, v214
    v_fma_f32 v215, v235, v24, v215
    v_fma_f32 v216, v236, v24, v216
    v_fma_f32 v217, v237, v24, v217
    v_fma_f32 v218, v238, v24, v218
    v_fma_f32 v219, v239, v24, v219
    v_fma_f32 v220, v240, v24, v220
    v_fma_f32 v221, v241, v24, v221
    v_fma_f32 v222, v242, v24, v222
    v_fma_f32 v223, v243, v24, v223
    v_fma_f32 v224, v244, v24, v224
    v_fma_f32 v225, v245, v24, v225
    v_fma_f32 v226, v246, v24, v226
    v_fma_f32 v227, v247, v24, v227
    v_fma_f32 v228, v248, v24, v228
    v_fma_f32 v229, v249, v24, v229
    v_fma_f32 v230, v250, v24, v230
    v_fma_f32 v231, v251, v24, v231
    s_waitcnt lgkmcnt(10)
    v_pk_add_f32 v[32:33], v[32:33], v[52:53]
    v_pk_add_f32 v[34:35], v[34:35], v[54:55]
    v_pk_add_f32 v[36:37], v[36:37], v[56:57]
    v_pk_add_f32 v[38:39], v[38:39], v[58:59]
    v_pk_add_f32 v[40:41], v[40:41], v[60:61]
    v_pk_add_f32 v[42:43], v[42:43], v[62:63]
    v_pk_add_f32 v[44:45], v[44:45], v[64:65]
    v_pk_add_f32 v[46:47], v[46:47], v[66:67]
    v_pk_add_f32 v[48:49], v[48:49], v[68:69]
    v_pk_add_f32 v[50:51], v[50:51], v[70:71]
    s_waitcnt lgkmcnt(5)
    v_pk_add_f32 v[32:33], v[32:33], v[72:73]
    v_pk_add_f32 v[34:35], v[34:35], v[74:75]
    v_pk_add_f32 v[36:37], v[36:37], v[76:77]
    v_pk_add_f32 v[38:39], v[38:39], v[78:79]
    v_pk_add_f32 v[40:41], v[40:41], v[80:81]
    v_pk_add_f32 v[42:43], v[42:43], v[82:83]
    v_pk_add_f32 v[44:45], v[44:45], v[84:85]
    v_pk_add_f32 v[46:47], v[46:47], v[86:87]
    v_pk_add_f32 v[48:49], v[48:49], v[88:89]
    v_pk_add_f32 v[50:51], v[50:51], v[90:91]
    s_waitcnt lgkmcnt(0)
    v_pk_add_f32 v[32:33], v[32:33], v[92:93]
    v_pk_add_f32 v[34:35], v[34:35], v[94:95]
    v_pk_add_f32 v[36:37], v[36:37], v[96:97]
    v_pk_add_f32 v[38:39], v[38:39], v[98:99]
    v_pk_add_f32 v[40:41], v[40:41], v[100:101]
    v_pk_add_f32 v[42:43], v[42:43], v[102:103]
    v_pk_add_f32 v[44:45], v[44:45], v[104:105]
    v_pk_add_f32 v[46:47], v[46:47], v[106:107]
    v_pk_add_f32 v[48:49], v[48:49], v[108:109]
    v_pk_add_f32 v[50:51], v[50:51], v[110:111]
    s_cmp_ge_u32 s15, 4
    s_cbranch_scc1 K3_mir
    v_sub_f32 v32, v32, v212
    v_sub_f32 v33, v33, v213
    v_sub_f32 v34, v34, v214
    v_sub_f32 v35, v35, v215
    v_fma_f32 v32, v32, v252, v212
    v_fma_f32 v33, v33, v252, v213
    v_fma_f32 v34, v34, v252, v214
    v_fma_f32 v35, v35, v252, v215
    v_sub_f32 v36, v36, v216
    v_sub_f32 v37, v37, v217
    v_sub_f32 v38, v38, v218
    v_sub_f32 v39, v39, v219
    v_fma_f32 v36, v36, v252, v216
    v_fma_f32 v37, v37, v252, v217
    v_fma_f32 v38, v38, v252, v218
    v_fma_f32 v39, v39, v252, v219
    v_sub_f32 v40, v40, v220
    v_sub_f32 v41, v41, v221
    v_sub_f32 v42, v42, v222
    v_sub_f32 v43, v43, v223
    v_fma_f32 v40, v40, v252, v220
    v_fma_f32 v41, v41, v252, v221
    v_fma_f32 v42, v42, v252, v222
    v_fma_f32 v43, v43, v252, v223
    v_sub_f32 v44, v44, v224
    v_sub_f32 v45, v45, v225
    v_sub_f32 v46, v46, v226
    v_sub_f32 v47, v47, v227
    v_fma_f32 v44, v44, v252, v224
    v_fma_f32 v45, v45, v252, v225
    v_fma_f32 v46, v46, v252, v226
    v_fma_f32 v47, v47, v252, v227
    v_sub_f32 v48, v48, v228
    v_sub_f32 v49, v49, v229
    v_sub_f32 v50, v50, v230
    v_sub_f32 v51, v51, v231
    v_fma_f32 v48, v48, v252, v228
    v_fma_f32 v49, v49, v252, v229
    v_fma_f32 v50, v50, v252, v230
    v_fma_f32 v51, v51, v252, v231
    s_branch K3_st
K3_mir:
    v_sub_f32 v32, v32, v215
    v_sub_f32 v33, v33, v214
    v_sub_f32 v34, v34, v213
    v_sub_f32 v35, v35, v212
    v_fma_f32 v32, v32, v252, v215
    v_fma_f32 v33, v33, v252, v214
    v_fma_f32 v34, v34, v252, v213
    v_fma_f32 v35, v35, v252, v212
    v_sub_f32 v36, v36, v219
    v_sub_f32 v37, v37, v218
    v_sub_f32 v38, v38, v217
    v_sub_f32 v39, v39, v216
    v_fma_f32 v36, v36, v252, v219
    v_fma_f32 v37, v37, v252, v218
    v_fma_f32 v38, v38, v252, v217
    v_fma_f32 v39, v39, v252, v216
    v_sub_f32 v40, v40, v223
    v_sub_f32 v41, v41, v222
    v_sub_f32 v42, v42, v221
    v_sub_f32 v43, v43, v220
    v_fma_f32 v40, v40, v252, v223
    v_fma_f32 v41, v41, v252, v222
    v_fma_f32 v42, v42, v252, v221
    v_fma_f32 v43, v43, v252, v220
    v_sub_f32 v44, v44, v227
    v_sub_f32 v45, v45, v226
    v_sub_f32 v46, v46, v225
    v_sub_f32 v47, v47, v224
    v_fma_f32 v44, v44, v252, v227
    v_fma_f32 v45, v45, v252, v226
    v_fma_f32 v46, v46, v252, v225
    v_fma_f32 v47, v47, v252, v224
    v_sub_f32 v48, v48, v231
    v_sub_f32 v49, v49, v230
    v_sub_f32 v50, v50, v229
    v_sub_f32 v51, v51, v228
    v_fma_f32 v48, v48, v252, v231
    v_fma_f32 v49, v49, v252, v230
    v_fma_f32 v50, v50, v252, v229
    v_fma_f32 v51, v51, v252, v228
K3_st:
    v_cvt_pk_bf16_f32 v52, v32, v33
    v_cvt_pk_bf16_f32 v53, v34, v35
    v_cvt_pk_bf16_f32 v54, v36, v37
    v_cvt_pk_bf16_f32 v55, v38, v39
    v_cvt_pk_bf16_f32 v56, v40, v41
    v_cvt_pk_bf16_f32 v57, v42, v43
    v_cvt_pk_bf16_f32 v58, v44, v45
    v_cvt_pk_bf16_f32 v59, v46, v47
    v_cvt_pk_bf16_f32 v60, v48, v49
    v_cvt_pk_bf16_f32 v61, v50, v51
    buffer_store_dwordx2 v[60:61], v19, s[4:7], 0 offen offset:128
    v_permlane16_swap_b32 v52, v54
    v_permlane16_swap_b32 v53, v55
    v_permlane16_swap_b32 v56, v58
    v_permlane16_swap_b32 v57, v59
    s_nop 1
    buffer_store_dwordx4 v[52:55], v18, s[4:7], 0 offen
    buffer_store_dwordx4 v[56:59], v18, s[4:7], 0 offen offset:64
K3_end:
    s_endpgm
TEXT_END:
    s_endpgm
.section .rodata,"a"
.p2align 6
.amdhsa_kernel k1_kernel
  .amdhsa_next_free_vgpr 208
  .amdhsa_next_free_sgpr 96
  .amdhsa_accum_offset 208
  .amdhsa_group_segment_fixed_size 0
  .amdhsa_kernarg_size 96
  .amdhsa_user_sgpr_count 2
  .amdhsa_user_sgpr_kernarg_segment_ptr 1
  .amdhsa_system_sgpr_workgroup_id_x 1
.end_amdhsa_kernel
.p2align 6
.amdhsa_kernel k2_kernel
  .amdhsa_next_free_vgpr 136
  .amdhsa_next_free_sgpr 96
  .amdhsa_accum_offset 136
  .amdhsa_group_segment_fixed_size 0
  .amdhsa_kernarg_size 96
  .amdhsa_user_sgpr_count 2
  .amdhsa_user_sgpr_kernarg_segment_ptr 1
  .amdhsa_system_sgpr_workgroup_id_x 1
.end_amdhsa_kernel
.p2align 6
.amdhsa_kernel k3_kernel
  .amdhsa_next_free_vgpr 336
  .amdhsa_next_free_sgpr 96
  .amdhsa_accum_offset 256
  .amdhsa_group_segment_fixed_size 0
  .amdhsa_kernarg_size 96
  .amdhsa_user_sgpr_count 2
  .amdhsa_user_sgpr_kernarg_segment_ptr 1
  .amdhsa_system_sgpr_workgroup_id_x 1
.end_amdhsa_kernel
```
